```python
import torch

def _softmax(x, axis=-1):
    return torch.softmax(x, dim=axis)
def _gelu(x):
    return torch.nn.functional.gelu(x, approximate="tanh")
def _silu(x):
    return torch.nn.functional.silu(x)
def _sigmoid(x):
    return torch.sigmoid(x)
def _layernorm(x, axis=-1, eps=1e-5):
    m = x.mean(dim=axis, keepdim=True)
    v = x.var(dim=axis, keepdim=True, unbiased=False)
    return (x - m) / torch.sqrt(v + eps)
def _scatter_add(tgt, idx, src, axis=0):
    return tgt.clone().index_add_(axis, idx, src)
def _segment_sum(src, seg, n):
    out = torch.zeros((n,) + src.shape[1:], dtype=src.dtype)
    return out.index_add_(0, seg, src)
def _pad(x, pw):
    flat = tuple(v for pair in reversed(pw) for v in pair)
    return torch.nn.functional.pad(x, flat)

kernel_name = 'gated_mix__compressed_kv_cla__dense_activation_squared_relu__decode'

def setup_inputs():

    _w = (lambda a: (lambda t: t.to(torch.bfloat16) if t.is_floating_point() else t)(torch.as_tensor(a)))
    def _A_setup():
        B, H, Sq, Sk, D, M = 2, 32, 1, 8192, 128, 576
        Dc = 4 * D
        return {
            "x": _w((lambda *s: torch.randn(*s, dtype=torch.bfloat16) * 0.05)(B, Sq, M)),
            "c_kv": _w((lambda *s: torch.randn(*s, dtype=torch.bfloat16) * 1.6)(B, Sk, Dc)),
            "w_q": _w((lambda *s: torch.randn(*s, dtype=torch.bfloat16) * 6.4)(M, H, D) * (M ** -0.5)),
            "w_uk": _w((lambda *s: torch.randn(*s, dtype=torch.bfloat16) * 6.4)(Dc, H, D) * (Dc ** -0.5)),
            "w_uv": _w((lambda *s: torch.randn(*s, dtype=torch.bfloat16) * 1.6)(Dc, H, D) * (Dc ** -0.5)),
            "w_o": _w((lambda *s: torch.randn(*s, dtype=torch.bfloat16) * 1.6)(H, D, M) * ((H * D) ** -0.5)),
        }
    _A_in = _A_setup()

    def _B_setup():
        B, S, D, F = 2, 1, 576, 4608
        return {
            "x": _w((lambda *s: torch.randn(*s, dtype=torch.bfloat16) * 0.05)(B, S, D)),
            "w1": _w((lambda *s: torch.randn(*s, dtype=torch.bfloat16) * 0.4)(D, F)),
            "b1": _w((lambda *s: torch.randn(*s, dtype=torch.bfloat16) * 0.2)(F)),
            "w2": _w((lambda *s: torch.randn(*s, dtype=torch.bfloat16) * 0.2)(F, D)),
            "b2": _w((lambda *s: torch.randn(*s, dtype=torch.bfloat16) * 0.2)(D)),
        }
    _B_in = _B_setup()

    return {
        "A_x": _A_in["x"],
        "A_c_kv": _A_in["c_kv"],
        "A_w_q": _A_in["w_q"],
        "A_w_uk": _A_in["w_uk"],
        "A_w_uv": _A_in["w_uv"],
        "A_w_o": _A_in["w_o"],
        "B_x": _B_in["x"],
        "B_w1": _B_in["w1"],
        "B_b1": _B_in["b1"],
        "B_w2": _B_in["w2"],
        "B_b2": _B_in["b2"],
        "gate_w": _w((lambda *s: torch.randn(*s, dtype=torch.bfloat16) * 0.05)(576) * 16.0),
    }

def reference(A_x, A_c_kv, A_w_q, A_w_uk, A_w_uv, A_w_o, B_x, B_w1, B_b1, B_w2, B_b2, gate_w):
    def _A_ref(x, c_kv, w_q, w_uk, w_uv, w_o):
        B, Sq, M = x.shape[0], x.shape[1], x.shape[2]
        Sk = c_kv.shape[1]
        H, D = w_q.shape[1], w_q.shape[2]
        q = torch.einsum("bqm,mhd->bhqd", x, w_q)
        k = torch.einsum("bkc,chd->bhkd", c_kv, w_uk)
        v = torch.einsum("bkc,chd->bhkd", c_kv, w_uv)
        scores = torch.einsum("bhqd,bhkd->bhqk", q, k) * (D ** -0.5)
        off = Sk - Sq
        qi = torch.arange(Sq)[:, None]
        kj = torch.arange(Sk)[None, :]
        cmask = kj <= (qi + off)
        scores = torch.where(cmask[None, None], scores, -1e9)
        p = _softmax(scores, axis=-1)
        ctx = torch.einsum("bhqk,bhkd->bhqd", p, v)
        return torch.einsum("bhqd,hdm->bqm", ctx, w_o)

    def _B_ref(x, w1, b1, w2, b2):
        h = torch.einsum("bsd,df->bsf", x, w1) + b1
        zero = torch.zeros_like(h)
        r = torch.where(h > zero, h, zero)
        h = r * r
        out = torch.einsum("bsf,fd->bsd", h, w2) + b2
        return out

    x = A_x
    g = _sigmoid((x * gate_w).sum(-1, keepdims=True))
    a = _A_ref(x, A_c_kv, A_w_q, A_w_uk, A_w_uv, A_w_o)
    b = _B_ref(x, B_w1, B_b1, B_w2, B_b2)
    return g * a + (1 - g) * b
```

```asm
; @launch grid=(256,1,1) block=(512,1,1) lds=163840
.amdgcn_target "amdgcn-amd-amdhsa--gfx950"
.text
.globl gated_mix__compressed_kv_cla__dense_activation_squared_relu__decode_kernel
.p2align 8
.type gated_mix__compressed_kv_cla__dense_activation_squared_relu__decode_kernel,@function
gated_mix__compressed_kv_cla__dense_activation_squared_relu__decode_kernel:
    s_cmp_ge_u32 s2, 256
    s_cbranch_scc1 L_end
    s_load_dwordx16 s[4:19], s[0:1], 0
    s_load_dwordx8 s[20:27], s[0:1], 64
    s_load_dwordx4 s[28:31], s[0:1], 96
    s_load_dwordx2 s[32:33], s[0:1], 112
    v_lshrrev_b32 v1, 6, v0
    v_and_b32 v2, 63, v0
    v_and_b32 v3, 15, v0
    v_bfe_u32 v4, v0, 4, 2
    v_readfirstlane_b32 s34, v1
    s_mov_b32 s37, 0x05040100
    s_mov_b32 s38, 0x07060302
    s_waitcnt lgkmcnt(0)
    s_load_dword s62, s[32:33], 0
    s_cmp_ge_u32 s2, 128
    s_cbranch_scc1 L_B
L_A:
    s_and_b32 s52, s34, 3
    s_lshr_b32 s53, s34, 2
    s_lshr_b32 s61, s2, 6
    s_lshl_b32 s40, s2, 17
    s_lshl_b32 s41, s52, 8
    s_add_u32 s40, s40, s41
    s_lshl_b32 s41, s53, 16
    s_add_u32 s40, s40, s41
    s_add_u32 s54, s6, s40
    s_addc_u32 s55, s7, 0
    s_lshl_b32 s56, s52, 15
    s_lshl_b32 s41, s53, 14
    s_add_u32 s56, s56, s41
    v_lshlrev_b32 v8, 2, v4
    v_xor_b32 v8, v8, v3
    v_xor_b32 v12, 0, v8
    v_lshlrev_b32 v12, 4, v12
    v_lshl_add_u32 v12, v4, 10, v12
    v_xor_b32 v13, 1, v8
    v_lshlrev_b32 v13, 4, v13
    v_lshl_add_u32 v13, v4, 10, v13
    v_add_u32 v13, 4096, v13
    v_xor_b32 v14, 2, v8
    v_lshlrev_b32 v14, 4, v14
    v_lshl_add_u32 v14, v4, 10, v14
    v_add_u32 v14, 8192, v14
    v_xor_b32 v15, 3, v8
    v_lshlrev_b32 v15, 4, v15
    v_lshl_add_u32 v15, v4, 10, v15
    v_add_u32 v15, 12288, v15
    s_add_u32 m0, s56, 0
    s_nop 0
    global_load_lds_dwordx4 v12, s[54:55] nt
    v_add_u32 v12, 16384, v12
    s_add_u32 m0, s56, 1024
    s_nop 0
    global_load_lds_dwordx4 v13, s[54:55] nt
    v_add_u32 v13, 16384, v13
    s_waitcnt vmcnt(1)
    s_add_u32 m0, s56, 2048
    s_nop 0
    global_load_lds_dwordx4 v14, s[54:55] nt
    v_add_u32 v14, 16384, v14
    s_waitcnt vmcnt(1)
    s_add_u32 m0, s56, 3072
    s_nop 0
    global_load_lds_dwordx4 v15, s[54:55] nt
    v_add_u32 v15, 16384, v15
    s_waitcnt vmcnt(1)
    s_add_u32 m0, s56, 4096
    s_nop 0
    global_load_lds_dwordx4 v12, s[54:55] nt
    v_add_u32 v12, 16384, v12
    s_waitcnt vmcnt(1)
    s_add_u32 m0, s56, 5120
    s_nop 0
    global_load_lds_dwordx4 v13, s[54:55] nt
    v_add_u32 v13, 16384, v13
    s_waitcnt vmcnt(1)
    s_add_u32 m0, s56, 6144
    s_nop 0
    global_load_lds_dwordx4 v14, s[54:55] nt
    v_add_u32 v14, 16384, v14
    s_waitcnt vmcnt(1)
    s_add_u32 m0, s56, 7168
    s_nop 0
    global_load_lds_dwordx4 v15, s[54:55] nt
    v_add_u32 v15, 16384, v15
    s_waitcnt vmcnt(1)
    s_add_u32 m0, s56, 8192
    s_nop 0
    global_load_lds_dwordx4 v12, s[54:55] nt
    v_add_u32 v12, 16384, v12
    s_waitcnt vmcnt(1)
    s_add_u32 m0, s56, 9216
    s_nop 0
    global_load_lds_dwordx4 v13, s[54:55] nt
    v_add_u32 v13, 16384, v13
    s_waitcnt vmcnt(1)
    s_add_u32 m0, s56, 10240
    s_nop 0
    global_load_lds_dwordx4 v14, s[54:55] nt
    v_add_u32 v14, 16384, v14
    s_waitcnt vmcnt(1)
    s_add_u32 m0, s56, 11264
    s_nop 0
    global_load_lds_dwordx4 v15, s[54:55] nt
    v_add_u32 v15, 16384, v15
    s_waitcnt vmcnt(1)
    s_add_u32 m0, s56, 12288
    s_nop 0
    global_load_lds_dwordx4 v12, s[54:55] nt
    s_waitcnt vmcnt(1)
    s_add_u32 m0, s56, 13312
    s_nop 0
    global_load_lds_dwordx4 v13, s[54:55] nt
    s_waitcnt vmcnt(1)
    s_add_u32 m0, s56, 14336
    s_nop 0
    global_load_lds_dwordx4 v14, s[54:55] nt
    s_waitcnt vmcnt(1)
    s_add_u32 m0, s56, 15360
    s_nop 0
    global_load_lds_dwordx4 v15, s[54:55] nt
    s_lshl_b32 s40, s61, 16
    s_add_u32 s40, s40, 65536
    v_lshlrev_b32 v8, 4, v0
    v_add_u32 v8, s40, v8
    s_waitcnt vmcnt(0)
    s_waitcnt lgkmcnt(0)
    s_mul_i32 s39, s62, 0x9E3779B1
    s_add_u32 s39, s39, 0x7F4A7C15
    v_mov_b32 v7, v8
    s_barrier
    v_and_b32 v8, 3, v3
    v_lshlrev_b32 v8, 2, v8
    v_lshrrev_b32 v9, 2, v3
    v_or_b32 v8, v8, v9
    v_xor_b32 v8, v8, v4
    s_lshr_b32 s40, s34, 1
    s_lshl_b32 s40, s40, 13
    v_lshl_add_u32 v9, v3, 8, s40
    v_xor_b32 v10, 0, v8
    v_lshl_add_u32 v12, v10, 4, v9
    v_add_u32 v216, 65536, v12
    v_xor_b32 v10, 4, v8
    v_lshl_add_u32 v13, v10, 4, v9
    v_add_u32 v217, 65536, v13
    v_xor_b32 v10, 8, v8
    v_lshl_add_u32 v14, v10, 4, v9
    v_add_u32 v218, 65536, v14
    v_xor_b32 v10, 12, v8
    v_lshl_add_u32 v15, v10, 4, v9
    v_add_u32 v219, 65536, v15
    ds_read_b128 v[16:19], v12 offset:0
    ds_read_b128 v[20:23], v13 offset:0
    ds_read_b128 v[24:27], v14 offset:0
    ds_read_b128 v[28:31], v15 offset:0
    ds_read_b128 v[32:35], v12 offset:32768
    ds_read_b128 v[36:39], v13 offset:32768
    ds_read_b128 v[40:43], v14 offset:32768
    ds_read_b128 v[44:47], v15 offset:32768
    ds_read_b128 v[48:51], v216 offset:0
    ds_read_b128 v[52:55], v217 offset:0
    ds_read_b128 v[56:59], v218 offset:0
    ds_read_b128 v[60:63], v219 offset:0
    ds_read_b128 v[64:67], v216 offset:32768
    ds_read_b128 v[68:71], v217 offset:32768
    ds_read_b128 v[72:75], v218 offset:32768
    ds_read_b128 v[76:79], v219 offset:32768
    ds_read_b128 v[80:83], v12 offset:4096
    ds_read_b128 v[84:87], v13 offset:4096
    ds_read_b128 v[88:91], v14 offset:4096
    ds_read_b128 v[92:95], v15 offset:4096
    ds_read_b128 v[96:99], v12 offset:36864
    ds_read_b128 v[100:103], v13 offset:36864
    ds_read_b128 v[104:107], v14 offset:36864
    ds_read_b128 v[108:111], v15 offset:36864
    ds_read_b128 v[112:115], v216 offset:4096
    ds_read_b128 v[116:119], v217 offset:4096
    ds_read_b128 v[120:123], v218 offset:4096
    ds_read_b128 v[124:127], v219 offset:4096
    ds_read_b128 v[128:131], v216 offset:36864
    ds_read_b128 v[132:135], v217 offset:36864
    ds_read_b128 v[136:139], v218 offset:36864
    ds_read_b128 v[140:143], v219 offset:36864
    s_mov_b32 s41, 0
L_poll1:
    s_sleep 24
    v_mov_b32 v9, v7
    global_load_dwordx4 v[220:223], v9, s[32:33] sc1
    v_add_u32 v9, 8192, v9
    global_load_dwordx4 v[224:227], v9, s[32:33] sc1
    v_add_u32 v9, 8192, v9
    global_load_dwordx4 v[228:231], v9, s[32:33] sc1
    v_add_u32 v9, 8192, v9
    global_load_dwordx4 v[232:235], v9, s[32:33] sc1
    v_add_u32 v9, 8192, v9
    global_load_dwordx4 v[236:239], v9, s[32:33] sc1
    v_add_u32 v9, 8192, v9
    global_load_dwordx4 v[240:243], v9, s[32:33] sc1
    v_add_u32 v9, 8192, v9
    global_load_dwordx4 v[244:247], v9, s[32:33] sc1
    v_add_u32 v9, 8192, v9
    global_load_dwordx4 v[248:251], v9, s[32:33] sc1
    s_add_u32 s41, s41, 1
    s_waitcnt vmcnt(0)
    s_mov_b64 s[58:59], 0
    v_cmp_ne_u32 vcc, s39, v221
    s_or_b64 s[58:59], s[58:59], vcc
    v_cmp_ne_u32 vcc, s39, v223
    s_or_b64 s[58:59], s[58:59], vcc
    v_cmp_ne_u32 vcc, s39, v225
    s_or_b64 s[58:59], s[58:59], vcc
    v_cmp_ne_u32 vcc, s39, v227
    s_or_b64 s[58:59], s[58:59], vcc
    v_cmp_ne_u32 vcc, s39, v229
    s_or_b64 s[58:59], s[58:59], vcc
    v_cmp_ne_u32 vcc, s39, v231
    s_or_b64 s[58:59], s[58:59], vcc
    v_cmp_ne_u32 vcc, s39, v233
    s_or_b64 s[58:59], s[58:59], vcc
    v_cmp_ne_u32 vcc, s39, v235
    s_or_b64 s[58:59], s[58:59], vcc
    v_cmp_ne_u32 vcc, s39, v237
    s_or_b64 s[58:59], s[58:59], vcc
    v_cmp_ne_u32 vcc, s39, v239
    s_or_b64 s[58:59], s[58:59], vcc
    v_cmp_ne_u32 vcc, s39, v241
    s_or_b64 s[58:59], s[58:59], vcc
    v_cmp_ne_u32 vcc, s39, v243
    s_or_b64 s[58:59], s[58:59], vcc
    v_cmp_ne_u32 vcc, s39, v245
    s_or_b64 s[58:59], s[58:59], vcc
    v_cmp_ne_u32 vcc, s39, v247
    s_or_b64 s[58:59], s[58:59], vcc
    v_cmp_ne_u32 vcc, s39, v249
    s_or_b64 s[58:59], s[58:59], vcc
    v_cmp_ne_u32 vcc, s39, v251
    s_or_b64 s[58:59], s[58:59], vcc
    s_cmp_gt_u32 s41, 32768
    s_cbranch_scc1 L_poll1_done
    s_cmp_lg_u64 s[58:59], 0
    s_cbranch_scc1 L_poll1
L_poll1_done:
    v_lshrrev_b32 v9, 7, v0
    v_bfe_u32 v10, v0, 1, 6
    v_and_b32 v11, 1, v0
    v_add_u32 v12, 0, v9
    v_and_b32 v13, 15, v12
    v_xor_b32 v13, v13, v10
    v_lshlrev_b32 v13, 4, v13
    v_lshl_add_u32 v13, v12, 10, v13
    v_lshl_add_u32 v13, v11, 3, v13
    v_add_u32 v13, 131072, v13
    v_mov_b32 v221, v222
    ds_write_b64 v13, v[220:221]
    v_add_u32 v12, 4, v9
    v_and_b32 v13, 15, v12
    v_xor_b32 v13, v13, v10
    v_lshlrev_b32 v13, 4, v13
    v_lshl_add_u32 v13, v12, 10, v13
    v_lshl_add_u32 v13, v11, 3, v13
    v_add_u32 v13, 131072, v13
    v_mov_b32 v225, v226
    ds_write_b64 v13, v[224:225]
    v_add_u32 v12, 8, v9
    v_and_b32 v13, 15, v12
    v_xor_b32 v13, v13, v10
    v_lshlrev_b32 v13, 4, v13
    v_lshl_add_u32 v13, v12, 10, v13
    v_lshl_add_u32 v13, v11, 3, v13
    v_add_u32 v13, 131072, v13
    v_mov_b32 v229, v230
    ds_write_b64 v13, v[228:229]
    v_add_u32 v12, 12, v9
    v_and_b32 v13, 15, v12
    v_xor_b32 v13, v13, v10
    v_lshlrev_b32 v13, 4, v13
    v_lshl_add_u32 v13, v12, 10, v13
    v_lshl_add_u32 v13, v11, 3, v13
    v_add_u32 v13, 131072, v13
    v_mov_b32 v233, v234
    ds_write_b64 v13, v[232:233]
    v_add_u32 v12, 16, v9
    v_and_b32 v13, 15, v12
    v_xor_b32 v13, v13, v10
    v_lshlrev_b32 v13, 4, v13
    v_lshl_add_u32 v13, v12, 10, v13
    v_lshl_add_u32 v13, v11, 3, v13
    v_add_u32 v13, 131072, v13
    v_mov_b32 v237, v238
    ds_write_b64 v13, v[236:237]
    v_add_u32 v12, 20, v9
    v_and_b32 v13, 15, v12
    v_xor_b32 v13, v13, v10
    v_lshlrev_b32 v13, 4, v13
    v_lshl_add_u32 v13, v12, 10, v13
    v_lshl_add_u32 v13, v11, 3, v13
    v_add_u32 v13, 131072, v13
    v_mov_b32 v241, v242
    ds_write_b64 v13, v[240:241]
    v_add_u32 v12, 24, v9
    v_and_b32 v13, 15, v12
    v_xor_b32 v13, v13, v10
    v_lshlrev_b32 v13, 4, v13
    v_lshl_add_u32 v13, v12, 10, v13
    v_lshl_add_u32 v13, v11, 3, v13
    v_add_u32 v13, 131072, v13
    v_mov_b32 v245, v246
    ds_write_b64 v13, v[244:245]
    v_add_u32 v12, 28, v9
    v_and_b32 v13, 15, v12
    v_xor_b32 v13, v13, v10
    v_lshlrev_b32 v13, 4, v13
    v_lshl_add_u32 v13, v12, 10, v13
    v_lshl_add_u32 v13, v11, 3, v13
    v_add_u32 v13, 131072, v13
    v_mov_b32 v249, v250
    ds_write_b64 v13, v[248:249]
    s_waitcnt lgkmcnt(0)
    s_barrier
    v_xor_b32 v10, v3, v4
    s_and_b32 s57, s34, 1
    s_lshl_b32 s40, s57, 14
    s_add_u32 s40, s40, 131072
    v_lshl_add_u32 v11, v3, 10, s40
    v_xor_b32 v9, 0, v10
    v_lshl_add_u32 v9, v9, 4, v11
    ds_read_b128 v[144:147], v9
    v_xor_b32 v9, 4, v10
    v_lshl_add_u32 v9, v9, 4, v11
    ds_read_b128 v[148:151], v9
    v_xor_b32 v9, 8, v10
    v_lshl_add_u32 v9, v9, 4, v11
    ds_read_b128 v[152:155], v9
    v_xor_b32 v9, 12, v10
    v_lshl_add_u32 v9, v9, 4, v11
    ds_read_b128 v[156:159], v9
    v_xor_b32 v9, 16, v10
    v_lshl_add_u32 v9, v9, 4, v11
    ds_read_b128 v[160:163], v9
    v_xor_b32 v9, 20, v10
    v_lshl_add_u32 v9, v9, 4, v11
    ds_read_b128 v[164:167], v9
    v_xor_b32 v9, 24, v10
    v_lshl_add_u32 v9, v9, 4, v11
    ds_read_b128 v[168:171], v9
    v_xor_b32 v9, 28, v10
    v_lshl_add_u32 v9, v9, 4, v11
    ds_read_b128 v[172:175], v9
    v_xor_b32 v9, 32, v10
    v_lshl_add_u32 v9, v9, 4, v11
    ds_read_b128 v[176:179], v9
    v_xor_b32 v9, 36, v10
    v_lshl_add_u32 v9, v9, 4, v11
    ds_read_b128 v[180:183], v9
    v_xor_b32 v9, 40, v10
    v_lshl_add_u32 v9, v9, 4, v11
    ds_read_b128 v[184:187], v9
    v_xor_b32 v9, 44, v10
    v_lshl_add_u32 v9, v9, 4, v11
    ds_read_b128 v[188:191], v9
    v_xor_b32 v9, 48, v10
    v_lshl_add_u32 v9, v9, 4, v11
    ds_read_b128 v[192:195], v9
    v_xor_b32 v9, 52, v10
    v_lshl_add_u32 v9, v9, 4, v11
    ds_read_b128 v[196:199], v9
    v_xor_b32 v9, 56, v10
    v_lshl_add_u32 v9, v9, 4, v11
    ds_read_b128 v[200:203], v9
    v_xor_b32 v9, 60, v10
    v_lshl_add_u32 v9, v9, 4, v11
    ds_read_b128 v[204:207], v9
    s_waitcnt lgkmcnt(15)
    v_mfma_f32_16x16x32_bf16 v[208:211], v[144:147], v[16:19], 0
    v_mfma_f32_16x16x32_bf16 v[212:215], v[144:147], v[80:83], 0
    s_waitcnt lgkmcnt(14)
    v_mfma_f32_16x16x32_bf16 v[208:211], v[148:151], v[20:23], v[208:211]
    v_mfma_f32_16x16x32_bf16 v[212:215], v[148:151], v[84:87], v[212:215]
    s_waitcnt lgkmcnt(13)
    v_mfma_f32_16x16x32_bf16 v[208:211], v[152:155], v[24:27], v[208:211]
    v_mfma_f32_16x16x32_bf16 v[212:215], v[152:155], v[88:91], v[212:215]
    s_waitcnt lgkmcnt(12)
    v_mfma_f32_16x16x32_bf16 v[208:211], v[156:159], v[28:31], v[208:211]
    v_mfma_f32_16x16x32_bf16 v[212:215], v[156:159], v[92:95], v[212:215]
    s_waitcnt lgkmcnt(11)
    v_mfma_f32_16x16x32_bf16 v[208:211], v[160:163], v[32:35], v[208:211]
    v_mfma_f32_16x16x32_bf16 v[212:215], v[160:163], v[96:99], v[212:215]
    s_waitcnt lgkmcnt(10)
    v_mfma_f32_16x16x32_bf16 v[208:211], v[164:167], v[36:39], v[208:211]
    v_mfma_f32_16x16x32_bf16 v[212:215], v[164:167], v[100:103], v[212:215]
    s_waitcnt lgkmcnt(9)
    v_mfma_f32_16x16x32_bf16 v[208:211], v[168:171], v[40:43], v[208:211]
    v_mfma_f32_16x16x32_bf16 v[212:215], v[168:171], v[104:107], v[212:215]
    s_waitcnt lgkmcnt(8)
    v_mfma_f32_16x16x32_bf16 v[208:211], v[172:175], v[44:47], v[208:211]
    v_mfma_f32_16x16x32_bf16 v[212:215], v[172:175], v[108:111], v[212:215]
    s_waitcnt lgkmcnt(7)
    v_mfma_f32_16x16x32_bf16 v[208:211], v[176:179], v[48:51], v[208:211]
    v_mfma_f32_16x16x32_bf16 v[212:215], v[176:179], v[112:115], v[212:215]
    s_waitcnt lgkmcnt(6)
    v_mfma_f32_16x16x32_bf16 v[208:211], v[180:183], v[52:55], v[208:211]
    v_mfma_f32_16x16x32_bf16 v[212:215], v[180:183], v[116:119], v[212:215]
    s_waitcnt lgkmcnt(5)
    v_mfma_f32_16x16x32_bf16 v[208:211], v[184:187], v[56:59], v[208:211]
    v_mfma_f32_16x16x32_bf16 v[212:215], v[184:187], v[120:123], v[212:215]
    s_waitcnt lgkmcnt(4)
    v_mfma_f32_16x16x32_bf16 v[208:211], v[188:191], v[60:63], v[208:211]
    v_mfma_f32_16x16x32_bf16 v[212:215], v[188:191], v[124:127], v[212:215]
    s_waitcnt lgkmcnt(3)
    v_mfma_f32_16x16x32_bf16 v[208:211], v[192:195], v[64:67], v[208:211]
    v_mfma_f32_16x16x32_bf16 v[212:215], v[192:195], v[128:131], v[212:215]
    s_waitcnt lgkmcnt(2)
    v_mfma_f32_16x16x32_bf16 v[208:211], v[196:199], v[68:71], v[208:211]
    v_mfma_f32_16x16x32_bf16 v[212:215], v[196:199], v[132:135], v[212:215]
    s_waitcnt lgkmcnt(1)
    v_mfma_f32_16x16x32_bf16 v[208:211], v[200:203], v[72:75], v[208:211]
    v_mfma_f32_16x16x32_bf16 v[212:215], v[200:203], v[136:139], v[212:215]
    s_waitcnt lgkmcnt(0)
    v_mfma_f32_16x16x32_bf16 v[208:211], v[204:207], v[76:79], v[208:211]
    v_mfma_f32_16x16x32_bf16 v[212:215], v[204:207], v[140:143], v[212:215]
    v_and_b32 v5, 31, v2
    v_lshrrev_b32 v6, 5, v2
    s_lshr_b32 s40, s34, 1
    s_lshl_b32 s40, s40, 15
    s_and_b32 s41, s34, 1
    s_lshl_b32 s41, s41, 1
    v_bfe_u32 v8, v2, 2, 2
    v_bfe_u32 v9, v2, 4, 1
    v_bfe_u32 v10, v2, 1, 1
    v_lshl_add_u32 v9, v9, 1, v10
    v_lshlrev_b32 v10, 1, v6
    v_xor_b32 v9, v9, v10
    v_lshl_add_u32 v10, v6, 3, v8
    v_lshlrev_b32 v10, 8, v10
    v_and_b32 v12, 1, v2
    v_lshl_add_u32 v10, v12, 3, v10
    v_add_u32 v10, s40, v10
    v_xor_b32 v8, s41, v8
    v_xor_b32 v12, 0, v8
    v_lshlrev_b32 v12, 2, v12
    v_xor_b32 v13, 0, v9
    v_add_u32 v12, v12, v13
    v_lshl_add_u32 v244, v12, 4, v10
    v_xor_b32 v12, 1, v8
    v_lshlrev_b32 v12, 2, v12
    v_xor_b32 v13, 0, v9
    v_add_u32 v12, v12, v13
    v_lshl_add_u32 v245, v12, 4, v10
    v_xor_b32 v12, 0, v8
    v_lshlrev_b32 v12, 2, v12
    v_xor_b32 v13, 1, v9
    v_add_u32 v12, v12, v13
    v_lshl_add_u32 v246, v12, 4, v10
    v_add_u32 v246, 1024, v246
    v_xor_b32 v12, 1, v8
    v_lshlrev_b32 v12, 2, v12
    v_xor_b32 v13, 1, v9
    v_add_u32 v12, v12, v13
    v_lshl_add_u32 v247, v12, 4, v10
    v_add_u32 v247, 1024, v247
    s_mov_b32 s40, 0x3db504f3
    v_cvt_pk_bf16_f32 v112, v208, v208
    v_lshlrev_b32 v112, 16, v112
    v_mul_f32 v112, s40, v112
    v_cvt_pk_bf16_f32 v112, v112, v112
    v_lshlrev_b32 v112, 16, v112
    v_cvt_pk_bf16_f32 v113, v209, v209
    v_lshlrev_b32 v113, 16, v113
    v_mul_f32 v113, s40, v113
    v_cvt_pk_bf16_f32 v113, v113, v113
    v_lshlrev_b32 v113, 16, v113
    v_cvt_pk_bf16_f32 v114, v210, v210
    v_lshlrev_b32 v114, 16, v114
    v_mul_f32 v114, s40, v114
    v_cvt_pk_bf16_f32 v114, v114, v114
    v_lshlrev_b32 v114, 16, v114
    v_cvt_pk_bf16_f32 v115, v211, v211
    v_lshlrev_b32 v115, 16, v115
    v_mul_f32 v115, s40, v115
    v_cvt_pk_bf16_f32 v115, v115, v115
    v_lshlrev_b32 v115, 16, v115
    v_cvt_pk_bf16_f32 v116, v212, v212
    v_lshlrev_b32 v116, 16, v116
    v_mul_f32 v116, s40, v116
    v_cvt_pk_bf16_f32 v116, v116, v116
    v_lshlrev_b32 v116, 16, v116
    v_cvt_pk_bf16_f32 v117, v213, v213
    v_lshlrev_b32 v117, 16, v117
    v_mul_f32 v117, s40, v117
    v_cvt_pk_bf16_f32 v117, v117, v117
    v_lshlrev_b32 v117, 16, v117
    v_cvt_pk_bf16_f32 v118, v214, v214
    v_lshlrev_b32 v118, 16, v118
    v_mul_f32 v118, s40, v118
    v_cvt_pk_bf16_f32 v118, v118, v118
    v_lshlrev_b32 v118, 16, v118
    v_cvt_pk_bf16_f32 v119, v215, v215
    v_lshlrev_b32 v119, 16, v119
    v_mul_f32 v119, s40, v119
    v_cvt_pk_bf16_f32 v119, v119, v119
    v_lshlrev_b32 v119, 16, v119
    v_max_f32 v120, v112, v116
    v_max_f32 v121, v113, v117
    v_max_f32 v122, v114, v118
    v_max_f32 v123, v115, v119
    s_nop 1
    v_max_f32_dpp v120, v120, v120 quad_perm:[1,0,3,2] row_mask:0xf bank_mask:0xf
    v_max_f32_dpp v121, v121, v121 quad_perm:[1,0,3,2] row_mask:0xf bank_mask:0xf
    v_max_f32_dpp v122, v122, v122 quad_perm:[1,0,3,2] row_mask:0xf bank_mask:0xf
    v_max_f32_dpp v123, v123, v123 quad_perm:[1,0,3,2] row_mask:0xf bank_mask:0xf
    s_nop 1
    v_max_f32_dpp v120, v120, v120 quad_perm:[2,3,0,1] row_mask:0xf bank_mask:0xf
    v_max_f32_dpp v121, v121, v121 quad_perm:[2,3,0,1] row_mask:0xf bank_mask:0xf
    v_max_f32_dpp v122, v122, v122 quad_perm:[2,3,0,1] row_mask:0xf bank_mask:0xf
    v_max_f32_dpp v123, v123, v123 quad_perm:[2,3,0,1] row_mask:0xf bank_mask:0xf
    s_nop 1
    v_max_f32_dpp v120, v120, v120 row_half_mirror row_mask:0xf bank_mask:0xf
    v_max_f32_dpp v121, v121, v121 row_half_mirror row_mask:0xf bank_mask:0xf
    v_max_f32_dpp v122, v122, v122 row_half_mirror row_mask:0xf bank_mask:0xf
    v_max_f32_dpp v123, v123, v123 row_half_mirror row_mask:0xf bank_mask:0xf
    s_nop 1
    v_max_f32_dpp v120, v120, v120 row_mirror row_mask:0xf bank_mask:0xf
    v_max_f32_dpp v121, v121, v121 row_mirror row_mask:0xf bank_mask:0xf
    v_max_f32_dpp v122, v122, v122 row_mirror row_mask:0xf bank_mask:0xf
    v_max_f32_dpp v123, v123, v123 row_mirror row_mask:0xf bank_mask:0xf
    s_barrier
    s_lshr_b32 s40, s34, 1
    s_lshl_b32 s40, s40, 7
    s_lshl_b32 s41, s57, 6
    s_add_u32 s40, s40, s41
    s_add_u32 s40, s40, 131072
    v_lshl_add_u32 v8, v4, 4, s40
    v_cmp_eq_u32 vcc, 0, v3
    s_and_saveexec_b64 s[58:59], vcc
    ds_write_b128 v8, v[120:123]
    s_mov_b64 exec, s[58:59]
    ds_read_b64_tr_b16 v[16:17], v244 offset:0
    ds_read_b64_tr_b16 v[18:19], v246 offset:0
    ds_read_b64_tr_b16 v[20:21], v244 offset:4096
    ds_read_b64_tr_b16 v[22:23], v246 offset:4096
    ds_read_b64_tr_b16 v[24:25], v244 offset:8192
    ds_read_b64_tr_b16 v[26:27], v246 offset:8192
    ds_read_b64_tr_b16 v[28:29], v244 offset:12288
    ds_read_b64_tr_b16 v[30:31], v246 offset:12288
    ds_read_b64_tr_b16 v[32:33], v244 offset:16384
    ds_read_b64_tr_b16 v[34:35], v246 offset:16384
    ds_read_b64_tr_b16 v[36:37], v244 offset:20480
    ds_read_b64_tr_b16 v[38:39], v246 offset:20480
    ds_read_b64_tr_b16 v[40:41], v244 offset:24576
    ds_read_b64_tr_b16 v[42:43], v246 offset:24576
    ds_read_b64_tr_b16 v[44:45], v244 offset:28672
    ds_read_b64_tr_b16 v[46:47], v246 offset:28672
    ds_read_b64_tr_b16 v[48:49], v245 offset:0
    ds_read_b64_tr_b16 v[50:51], v247 offset:0
    ds_read_b64_tr_b16 v[52:53], v245 offset:4096
    ds_read_b64_tr_b16 v[54:55], v247 offset:4096
    ds_read_b64_tr_b16 v[56:57], v245 offset:8192
    ds_read_b64_tr_b16 v[58:59], v247 offset:8192
    ds_read_b64_tr_b16 v[60:61], v245 offset:12288
    ds_read_b64_tr_b16 v[62:63], v247 offset:12288
    ds_read_b64_tr_b16 v[64:65], v245 offset:16384
    ds_read_b64_tr_b16 v[66:67], v247 offset:16384
    ds_read_b64_tr_b16 v[68:69], v245 offset:20480
    ds_read_b64_tr_b16 v[70:71], v247 offset:20480
    ds_read_b64_tr_b16 v[72:73], v245 offset:24576
    ds_read_b64_tr_b16 v[74:75], v247 offset:24576
    ds_read_b64_tr_b16 v[76:77], v245 offset:28672
    ds_read_b64_tr_b16 v[78:79], v247 offset:28672
    s_waitcnt lgkmcnt(15)
    s_waitcnt lgkmcnt(0)
    s_barrier
    s_add_u32 s41, s41, 131072
    v_lshl_add_u32 v9, v4, 4, s41
    ds_read_b128 v[124:127], v9 offset:0
    ds_read_b128 v[128:131], v9 offset:128
    ds_read_b128 v[132:135], v9 offset:256
    ds_read_b128 v[136:139], v9 offset:384
    s_waitcnt lgkmcnt(0)
    v_max3_f32 v120, v124, v128, v132
    v_max_f32 v120, v120, v136
    v_max3_f32 v121, v125, v129, v133
    v_max_f32 v121, v121, v137
    v_max3_f32 v122, v126, v130, v134
    v_max_f32 v122, v122, v138
    v_max3_f32 v123, v127, v131, v135
    v_max_f32 v123, v123, v139
    s_mov_b32 s41, 0x3fb8aa3b
    v_sub_f32 v112, v112, v120
    v_mul_f32 v112, s41, v112
    v_exp_f32 v112, v112
    v_sub_f32 v113, v113, v121
    v_mul_f32 v113, s41, v113
    v_exp_f32 v113, v113
    v_sub_f32 v114, v114, v122
    v_mul_f32 v114, s41, v114
    v_exp_f32 v114, v114
    v_sub_f32 v115, v115, v123
    v_mul_f32 v115, s41, v115
    v_exp_f32 v115, v115
    v_sub_f32 v116, v116, v120
    v_mul_f32 v116, s41, v116
    v_exp_f32 v116, v116
    v_sub_f32 v117, v117, v121
    v_mul_f32 v117, s41, v117
    v_exp_f32 v117, v117
    v_sub_f32 v118, v118, v122
    v_mul_f32 v118, s41, v118
    v_exp_f32 v118, v118
    v_sub_f32 v119, v119, v123
    v_mul_f32 v119, s41, v119
    v_exp_f32 v119, v119
    s_nop 0
    v_mul_u32_u24 v9, 1088, v4
    s_lshr_b32 s40, s34, 1
    s_lshl_b32 s40, s40, 6
    s_mul_i32 s41, s57, 4352
    s_add_u32 s40, s40, s41
    s_add_u32 s40, s40, 133120
    v_lshl_add_u32 v9, v3, 1, v9
    v_add_u32 v9, s40, v9
    v_cvt_pk_bf16_f32 v124, v112, v112
    ds_write_b16 v9, v124 offset:0
    v_cvt_pk_bf16_f32 v125, v113, v113
    ds_write_b16 v9, v125 offset:272
    v_cvt_pk_bf16_f32 v126, v114, v114
    ds_write_b16 v9, v126 offset:544
    v_cvt_pk_bf16_f32 v127, v115, v115
    ds_write_b16 v9, v127 offset:816
    v_cvt_pk_bf16_f32 v128, v116, v116
    ds_write_b16 v9, v128 offset:32
    v_cvt_pk_bf16_f32 v129, v117, v117
    ds_write_b16 v9, v129 offset:304
    v_cvt_pk_bf16_f32 v130, v118, v118
    ds_write_b16 v9, v130 offset:576
    v_cvt_pk_bf16_f32 v131, v119, v119
    ds_write_b16 v9, v131 offset:848
    v_add_f32 v112, v112, v116
    v_add_f32 v113, v113, v117
    v_add_f32 v114, v114, v118
    v_add_f32 v115, v115, v119
    s_nop 1
    v_add_f32_dpp v112, v112, v112 quad_perm:[1,0,3,2] row_mask:0xf bank_mask:0xf
    v_add_f32_dpp v113, v113, v113 quad_perm:[1,0,3,2] row_mask:0xf bank_mask:0xf
    v_add_f32_dpp v114, v114, v114 quad_perm:[1,0,3,2] row_mask:0xf bank_mask:0xf
    v_add_f32_dpp v115, v115, v115 quad_perm:[1,0,3,2] row_mask:0xf bank_mask:0xf
    s_nop 1
    v_add_f32_dpp v112, v112, v112 quad_perm:[2,3,0,1] row_mask:0xf bank_mask:0xf
    v_add_f32_dpp v113, v113, v113 quad_perm:[2,3,0,1] row_mask:0xf bank_mask:0xf
    v_add_f32_dpp v114, v114, v114 quad_perm:[2,3,0,1] row_mask:0xf bank_mask:0xf
    v_add_f32_dpp v115, v115, v115 quad_perm:[2,3,0,1] row_mask:0xf bank_mask:0xf
    s_nop 1
    v_add_f32_dpp v112, v112, v112 row_half_mirror row_mask:0xf bank_mask:0xf
    v_add_f32_dpp v113, v113, v113 row_half_mirror row_mask:0xf bank_mask:0xf
    v_add_f32_dpp v114, v114, v114 row_half_mirror row_mask:0xf bank_mask:0xf
    v_add_f32_dpp v115, v115, v115 row_half_mirror row_mask:0xf bank_mask:0xf
    s_nop 1
    v_add_f32_dpp v112, v112, v112 row_mirror row_mask:0xf bank_mask:0xf
    v_add_f32_dpp v113, v113, v113 row_mirror row_mask:0xf bank_mask:0xf
    v_add_f32_dpp v114, v114, v114 row_mirror row_mask:0xf bank_mask:0xf
    v_add_f32_dpp v115, v115, v115 row_mirror row_mask:0xf bank_mask:0xf
    s_and_saveexec_b64 s[58:59], vcc
    ds_write_b128 v8, v[112:115] offset:1024
    s_mov_b64 exec, s[58:59]
    s_waitcnt lgkmcnt(0)
    s_barrier
    v_and_b32 v5, 31, v2
    v_lshrrev_b32 v6, 5, v2
    v_mul_u32_u24 v8, 272, v5
    v_lshl_add_u32 v8, v6, 4, v8
    v_add_u32 v8, 133120, v8
    ds_read_b128 v[80:83], v8 offset:0
    ds_read_b128 v[84:87], v8 offset:32
    ds_read_b128 v[88:91], v8 offset:64
    ds_read_b128 v[92:95], v8 offset:96
    ds_read_b128 v[96:99], v8 offset:128
    ds_read_b128 v[100:103], v8 offset:160
    ds_read_b128 v[104:107], v8 offset:192
    ds_read_b128 v[108:111], v8 offset:224
    v_lshlrev_b32 v9, 2, v5
    v_add_u32 v9, 131072, v9
    ds_read_b32 v200, v9 offset:0
    ds_read_b32 v208, v9 offset:1024
    ds_read_b32 v201, v9 offset:128
    ds_read_b32 v209, v9 offset:1152
    ds_read_b32 v202, v9 offset:256
    ds_read_b32 v210, v9 offset:1280
    ds_read_b32 v203, v9 offset:384
    ds_read_b32 v211, v9 offset:1408
    s_waitcnt lgkmcnt(15)
    s_waitcnt lgkmcnt(0)
    v_mfma_f32_32x32x16_bf16 v[160:175], v[16:19], v[80:83], 0
    v_mfma_f32_32x32x16_bf16 v[160:175], v[20:23], v[84:87], v[160:175]
    v_mfma_f32_32x32x16_bf16 v[160:175], v[24:27], v[88:91], v[160:175]
    v_mfma_f32_32x32x16_bf16 v[160:175], v[28:31], v[92:95], v[160:175]
    v_mfma_f32_32x32x16_bf16 v[160:175], v[32:35], v[96:99], v[160:175]
    v_mfma_f32_32x32x16_bf16 v[160:175], v[36:39], v[100:103], v[160:175]
    v_mfma_f32_32x32x16_bf16 v[160:175], v[40:43], v[104:107], v[160:175]
    v_mfma_f32_32x32x16_bf16 v[160:175], v[44:47], v[108:111], v[160:175]
    s_waitcnt lgkmcnt(0)
    v_mfma_f32_32x32x16_bf16 v[176:191], v[48:51], v[80:83], 0
    v_mfma_f32_32x32x16_bf16 v[176:191], v[52:55], v[84:87], v[176:191]
    v_mfma_f32_32x32x16_bf16 v[176:191], v[56:59], v[88:91], v[176:191]
    v_mfma_f32_32x32x16_bf16 v[176:191], v[60:63], v[92:95], v[176:191]
    v_mfma_f32_32x32x16_bf16 v[176:191], v[64:67], v[96:99], v[176:191]
    v_mfma_f32_32x32x16_bf16 v[176:191], v[68:71], v[100:103], v[176:191]
    v_mfma_f32_32x32x16_bf16 v[176:191], v[72:75], v[104:107], v[176:191]
    v_mfma_f32_32x32x16_bf16 v[176:191], v[76:79], v[108:111], v[176:191]
    v_max_f32 v200, v200, v201
    v_add_f32 v208, v208, v209
    v_max_f32 v200, v200, v202
    v_add_f32 v208, v208, v210
    v_max_f32 v200, v200, v203
    v_add_f32 v208, v208, v211
    s_nop 7
    v_mov_b32 v201, v208
    v_mov_b32 v202, s39
    v_mov_b32 v203, s39
    s_mul_i32 s40, s34, 4608
    v_mul_u32_u24 v8, 144, v5
    v_lshl_add_u32 v8, v6, 3, v8
    v_add_u32 v8, s40, v8
    v_cvt_pk_bf16_f32 v160, v160, v161
    v_cvt_pk_bf16_f32 v161, v162, v163
    ds_write_b64 v8, v[160:161] offset:0
    v_cvt_pk_bf16_f32 v164, v164, v165
    v_cvt_pk_bf16_f32 v165, v166, v167
    ds_write_b64 v8, v[164:165] offset:16
    v_cvt_pk_bf16_f32 v168, v168, v169
    v_cvt_pk_bf16_f32 v169, v170, v171
    ds_write_b64 v8, v[168:169] offset:32
    v_cvt_pk_bf16_f32 v172, v172, v173
    v_cvt_pk_bf16_f32 v173, v174, v175
    ds_write_b64 v8, v[172:173] offset:48
    v_cvt_pk_bf16_f32 v176, v176, v177
    v_cvt_pk_bf16_f32 v177, v178, v179
    ds_write_b64 v8, v[176:177] offset:64
    v_cvt_pk_bf16_f32 v180, v180, v181
    v_cvt_pk_bf16_f32 v181, v182, v183
    ds_write_b64 v8, v[180:181] offset:80
    v_cvt_pk_bf16_f32 v184, v184, v185
    v_cvt_pk_bf16_f32 v185, v186, v187
    ds_write_b64 v8, v[184:185] offset:96
    v_cvt_pk_bf16_f32 v188, v188, v189
    v_cvt_pk_bf16_f32 v189, v190, v191
    ds_write_b64 v8, v[188:189] offset:112
    s_waitcnt lgkmcnt(0)
    v_lshrrev_b32 v8, 3, v2
    v_and_b32 v9, 7, v2
    v_mul_u32_u24 v10, 144, v8
    v_lshl_add_u32 v10, v9, 4, v10
    v_add_u32 v10, s40, v10
    ds_read_b128 v[48:51], v10 offset:0
    ds_read_b128 v[52:55], v10 offset:1152
    ds_read_b128 v[56:59], v10 offset:2304
    ds_read_b128 v[60:63], v10 offset:3456
    s_lshl_b32 s40, s2, 8
    s_lshr_b32 s41, s34, 1
    s_lshl_b32 s41, s41, 15
    s_add_u32 s40, s40, s41
    s_and_b32 s41, s34, 1
    s_lshl_b32 s41, s41, 7
    s_add_u32 s40, s40, s41
    s_add_u32 s40, s40, 8388608
    v_lshlrev_b32 v10, 17, v8
    v_lshl_add_u32 v10, v9, 4, v10
    v_add_u32 v10, s40, v10
    s_waitcnt lgkmcnt(3)
    global_store_dwordx4 v10, v[48:51], s[32:33] sc1
    v_add_u32 v10, 0x100000, v10
    s_waitcnt lgkmcnt(2)
    global_store_dwordx4 v10, v[52:55], s[32:33] sc1
    v_add_u32 v10, 0x100000, v10
    s_waitcnt lgkmcnt(1)
    global_store_dwordx4 v10, v[56:59], s[32:33] sc1
    v_add_u32 v10, 0x100000, v10
    s_waitcnt lgkmcnt(0)
    global_store_dwordx4 v10, v[60:63], s[32:33] sc1
    s_waitcnt vmcnt(0)
    s_barrier
    s_cmp_lg_u32 s34, 0
    s_cbranch_scc1 L_A_nostat
    s_lshl_b32 s40, s2, 9
    s_add_u32 s40, s40, 196608
    v_lshl_add_u32 v10, v2, 4, s40
    s_mov_b64 exec, 0xffffffff
    global_store_dwordx4 v10, v[200:203], s[32:33] sc1
    s_mov_b64 exec, -1
L_A_nostat:
    s_cmp_ge_u32 s34, 6
    s_cbranch_scc1 L_A_noffn2
    s_mul_i32 s48, s2, 6
    s_add_u32 s48, s48, s34
    s_min_u32 s41, s48, 719
    s_mul_i32 s40, s41, 52429
    s_lshr_b32 s51, s40, 18
    s_mul_i32 s40, s51, 5
    s_sub_u32 s46, s41, s40
    s_cmp_eq_u32 s46, 4
    s_cselect_b32 s40, 7, 15
    v_and_b32 v8, s40, v3
    v_lshlrev_b32 v8, 4, v8
    s_lshl_b32 s40, s46, 8
    v_add_u32 v8, s40, v8
    s_lshl_b32 s41, s51, 5
    v_lshl_add_u32 v7, v4, 3, s41
    v_mul_u32_u24 v7, 1152, v7
    v_add_u32 v7, v7, v8
    global_load_dwordx4 v[224:227], v7, s[22:23] offset:0 nt
    global_load_dwordx4 v[228:231], v7, s[22:23] offset:1152 nt
    global_load_dwordx4 v[232:235], v7, s[22:23] offset:2304 nt
    v_add_u32 v7, 3456, v7
    global_load_dwordx4 v[236:239], v7, s[22:23] offset:0 nt
    global_load_dwordx4 v[240:243], v7, s[22:23] offset:1152 nt
    global_load_dwordx4 v[244:247], v7, s[22:23] offset:2304 nt
    v_add_u32 v7, 3456, v7
    global_load_dwordx4 v[248:251], v7, s[22:23] offset:0 nt
    global_load_dwordx4 v[252:255], v7, s[22:23] offset:1152 nt
    s_cmp_ge_u32 s48, 720
    s_cbranch_scc1 L_A_noffn2
    v_lshrrev_b32 v8, 5, v2
    v_mul_u32_u24 v8, 36864, v8
    v_bfe_u32 v9, v2, 1, 4
    v_lshl_add_u32 v8, v9, 4, v8
    v_and_b32 v9, 1, v2
    s_mov_b32 s40, 663552
    v_mul_lo_u32 v9, v9, s40
    v_add_u32 v8, v8, v9
    s_lshl_b32 s40, s51, 8
    s_add_u32 s40, s40, 1376256
    v_add_u32 v8, s40, v8
    v_bfe_u32 v9, v2, 1, 4
    v_lshlrev_b32 v9, 2, v9
    s_lshl_b32 s40, s51, 6
    v_add_u32 v9, s40, v9
    global_load_dword v60, v9, s[20:21]
    s_mov_b32 s41, 0
L_pollh:
    s_sleep 8
    v_mov_b32 v9, v8
    global_load_dwordx4 v[16:19], v9, s[32:33] sc1
    v_add_u32 v9, 73728, v9
    global_load_dwordx4 v[20:23], v9, s[32:33] sc1
    v_add_u32 v9, 73728, v9
    global_load_dwordx4 v[24:27], v9, s[32:33] sc1
    v_add_u32 v9, 73728, v9
    global_load_dwordx4 v[28:31], v9, s[32:33] sc1
    v_add_u32 v9, 73728, v9
    global_load_dwordx4 v[32:35], v9, s[32:33] sc1
    v_add_u32 v9, 73728, v9
    global_load_dwordx4 v[36:39], v9, s[32:33] sc1
    v_add_u32 v9, 73728, v9
    global_load_dwordx4 v[40:43], v9, s[32:33] sc1
    v_add_u32 v9, 73728, v9
    global_load_dwordx4 v[44:47], v9, s[32:33] sc1
    v_add_u32 v9, 73728, v9
    global_load_dwordx4 v[48:51], v9, s[32:33] sc1
    s_add_u32 s41, s41, 1
    s_waitcnt vmcnt(0)
    s_mov_b64 s[58:59], 0
    v_cmp_ne_u32 vcc, s39, v17
    s_or_b64 s[58:59], s[58:59], vcc
    v_cmp_ne_u32 vcc, s39, v19
    s_or_b64 s[58:59], s[58:59], vcc
    v_cmp_ne_u32 vcc, s39, v21
    s_or_b64 s[58:59], s[58:59], vcc
    v_cmp_ne_u32 vcc, s39, v23
    s_or_b64 s[58:59], s[58:59], vcc
    v_cmp_ne_u32 vcc, s39, v25
    s_or_b64 s[58:59], s[58:59], vcc
    v_cmp_ne_u32 vcc, s39, v27
    s_or_b64 s[58:59], s[58:59], vcc
    v_cmp_ne_u32 vcc, s39, v29
    s_or_b64 s[58:59], s[58:59], vcc
    v_cmp_ne_u32 vcc, s39, v31
    s_or_b64 s[58:59], s[58:59], vcc
    v_cmp_ne_u32 vcc, s39, v33
    s_or_b64 s[58:59], s[58:59], vcc
    v_cmp_ne_u32 vcc, s39, v35
    s_or_b64 s[58:59], s[58:59], vcc
    v_cmp_ne_u32 vcc, s39, v37
    s_or_b64 s[58:59], s[58:59], vcc
    v_cmp_ne_u32 vcc, s39, v39
    s_or_b64 s[58:59], s[58:59], vcc
    v_cmp_ne_u32 vcc, s39, v41
    s_or_b64 s[58:59], s[58:59], vcc
    v_cmp_ne_u32 vcc, s39, v43
    s_or_b64 s[58:59], s[58:59], vcc
    v_cmp_ne_u32 vcc, s39, v45
    s_or_b64 s[58:59], s[58:59], vcc
    v_cmp_ne_u32 vcc, s39, v47
    s_or_b64 s[58:59], s[58:59], vcc
    v_cmp_ne_u32 vcc, s39, v49
    s_or_b64 s[58:59], s[58:59], vcc
    v_cmp_ne_u32 vcc, s39, v51
    s_or_b64 s[58:59], s[58:59], vcc
    s_cmp_gt_u32 s41, 32768
    s_cbranch_scc1 L_pollh_done
    s_cmp_lg_u64 s[58:59], 0
    s_cbranch_scc1 L_pollh
L_pollh_done:
    v_add_f32 v16, v16, v20
    v_add_f32 v18, v18, v22
    v_add_f32 v16, v16, v24
    v_add_f32 v18, v18, v26
    v_add_f32 v16, v16, v28
    v_add_f32 v18, v18, v30
    v_add_f32 v16, v16, v32
    v_add_f32 v18, v18, v34
    v_add_f32 v16, v16, v36
    v_add_f32 v18, v18, v38
    v_add_f32 v16, v16, v40
    v_add_f32 v18, v18, v42
    v_add_f32 v16, v16, v44
    v_add_f32 v18, v18, v46
    v_add_f32 v16, v16, v48
    v_add_f32 v18, v18, v50
    s_nop 1
    v_add_f32_dpp v16, v16, v16 quad_perm:[1,0,3,2] row_mask:0xf bank_mask:0xf
    v_add_f32_dpp v18, v18, v18 quad_perm:[1,0,3,2] row_mask:0xf bank_mask:0xf
    v_lshlrev_b32 v61, 16, v60
    v_and_b32 v62, 0xffff0000, v60
    v_cvt_pk_bf16_f32 v16, v16, v16
    v_lshlrev_b32 v16, 16, v16
    v_add_f32 v16, v16, v61
    v_cvt_pk_bf16_f32 v16, v16, v16
    v_lshlrev_b32 v16, 16, v16
    v_max_f32 v16, 0, v16
    v_mul_f32 v16, v16, v16
    v_cvt_pk_bf16_f32 v18, v18, v18
    v_lshlrev_b32 v18, 16, v18
    v_add_f32 v18, v18, v62
    v_cvt_pk_bf16_f32 v18, v18, v18
    v_lshlrev_b32 v18, 16, v18
    v_max_f32 v18, 0, v18
    v_mul_f32 v18, v18, v18
    v_cvt_pk_bf16_f32 v16, v16, v18
    s_lshl_b32 s40, s34, 8
    s_add_u32 s47, s40, 49152
    v_lshrrev_b32 v9, 1, v2
    v_lshl_add_u32 v9, v9, 2, s47
    ds_write_b32 v9, v16
    v_and_b32 v9, 1, v3
    v_lshlrev_b32 v9, 6, v9
    v_lshl_add_u32 v9, v4, 4, v9
    v_add_u32 v9, s47, v9
    s_waitcnt lgkmcnt(0)
    ds_read_b128 v[12:15], v9
    s_waitcnt lgkmcnt(0)
    v_perm_b32 v24, v228, v224, s37
    v_perm_b32 v25, v236, v232, s37
    v_perm_b32 v26, v244, v240, s37
    v_perm_b32 v27, v252, v248, s37
    v_perm_b32 v28, v228, v224, s38
    v_perm_b32 v29, v236, v232, s38
    v_perm_b32 v30, v244, v240, s38
    v_perm_b32 v31, v252, v248, s38
    v_perm_b32 v32, v229, v225, s37
    v_perm_b32 v33, v237, v233, s37
    v_perm_b32 v34, v245, v241, s37
    v_perm_b32 v35, v253, v249, s37
    v_perm_b32 v36, v229, v225, s38
    v_perm_b32 v37, v237, v233, s38
    v_perm_b32 v38, v245, v241, s38
    v_perm_b32 v39, v253, v249, s38
    v_perm_b32 v40, v230, v226, s37
    v_perm_b32 v41, v238, v234, s37
    v_perm_b32 v42, v246, v242, s37
    v_perm_b32 v43, v254, v250, s37
    v_perm_b32 v44, v230, v226, s38
    v_perm_b32 v45, v238, v234, s38
    v_perm_b32 v46, v246, v242, s38
    v_perm_b32 v47, v254, v250, s38
    v_perm_b32 v48, v231, v227, s37
    v_perm_b32 v49, v239, v235, s37
    v_perm_b32 v50, v247, v243, s37
    v_perm_b32 v51, v255, v251, s37
    v_perm_b32 v52, v231, v227, s38
    v_perm_b32 v53, v239, v235, s38
    v_perm_b32 v54, v247, v243, s38
    v_perm_b32 v55, v255, v251, s38
    s_nop 1
    v_mfma_f32_16x16x32_bf16 v[56:59], v[12:15], v[24:27], 0
    v_mfma_f32_16x16x32_bf16 v[60:63], v[12:15], v[28:31], 0
    v_mfma_f32_16x16x32_bf16 v[64:67], v[12:15], v[32:35], 0
    v_mfma_f32_16x16x32_bf16 v[68:71], v[12:15], v[36:39], 0
    v_mfma_f32_16x16x32_bf16 v[72:75], v[12:15], v[40:43], 0
    v_mfma_f32_16x16x32_bf16 v[76:79], v[12:15], v[44:47], 0
    v_mfma_f32_16x16x32_bf16 v[80:83], v[12:15], v[48:51], 0
    v_mfma_f32_16x16x32_bf16 v[84:87], v[12:15], v[52:55], 0
    s_add_u32 s43, s51, 128
    s_lshl_b32 s40, s43, 7
    s_mul_i32 s41, s46, 278528
    s_add_u32 s40, s40, s41
    s_add_u32 s40, s40, 3145728
    v_lshrrev_b32 v8, 3, v2
    v_mul_u32_u24 v8, 34816, v8
    v_and_b32 v9, 7, v2
    v_lshl_add_u32 v8, v9, 4, v8
    v_add_u32 v8, s40, v8
    s_nop 3
    v_mov_b32 v24, v56
    v_mov_b32 v25, s39
    v_mov_b32 v26, v60
    v_mov_b32 v27, s39
    v_mov_b32 v28, v64
    v_mov_b32 v29, s39
    v_mov_b32 v30, v68
    v_mov_b32 v31, s39
    v_mov_b32 v32, v72
    v_mov_b32 v33, s39
    v_mov_b32 v34, v76
    v_mov_b32 v35, s39
    v_mov_b32 v36, v80
    v_mov_b32 v37, s39
    v_mov_b32 v38, v84
    v_mov_b32 v39, s39
    v_mov_b32 v40, v57
    v_mov_b32 v41, s39
    v_mov_b32 v42, v61
    v_mov_b32 v43, s39
    v_mov_b32 v44, v65
    v_mov_b32 v45, s39
    v_mov_b32 v46, v69
    v_mov_b32 v47, s39
    v_mov_b32 v48, v73
    v_mov_b32 v49, s39
    v_mov_b32 v50, v77
    v_mov_b32 v51, s39
    v_mov_b32 v52, v81
    v_mov_b32 v53, s39
    v_mov_b32 v54, v85
    v_mov_b32 v55, s39
    s_lshl_b32 s42, s34, 11
    s_add_u32 s42, s42, 65536
    v_lshl_add_u32 v9, v3, 6, s42
    s_mov_b64 exec, 0xffff
    ds_write_b128 v9, v[24:27] offset:0
    ds_write_b128 v9, v[28:31] offset:16
    ds_write_b128 v9, v[32:35] offset:32
    ds_write_b128 v9, v[36:39] offset:48
    ds_write_b128 v9, v[40:43] offset:1024
    ds_write_b128 v9, v[44:47] offset:1040
    ds_write_b128 v9, v[48:51] offset:1056
    ds_write_b128 v9, v[52:55] offset:1072
    s_mov_b64 exec, -1
    v_lshl_add_u32 v9, v2, 4, s42
    s_waitcnt lgkmcnt(0)
    ds_read_b128 v[24:27], v9
    ds_read_b128 v[28:31], v9 offset:1024
    v_add_u32 v9, 1392640, v8
    s_waitcnt lgkmcnt(1)
    global_store_dwordx4 v8, v[24:27], s[32:33] sc1
    s_waitcnt lgkmcnt(0)
    global_store_dwordx4 v9, v[28:31], s[32:33] sc1
L_A_noffn2:
    s_cmp_ge_u32 s2, 72
    s_cbranch_scc1 L_fin
    s_cmp_ge_u32 s2, 36
    s_cselect_b32 s61, 1, 0
    s_mul_i32 s40, s61, 36
    s_sub_u32 s62, s2, s40
    v_lshrrev_b32 v8, 3, v0
    v_lshlrev_b32 v9, 4, v0
    s_mul_i32 s40, s61, 40
    s_add_u32 s40, s40, s62
    s_mul_i32 s40, s40, 34816
    s_add_u32 s40, s40, 3145728
    v_add_u32 v9, s40, v9
    v_and_b32 v12, 127, v0
    v_lshlrev_b32 v12, 4, v12
    v_add_u32 v12, s40, v12
    v_add_u32 v12, 32768, v12
    s_mul_i32 s40, s61, 1152
    v_lshlrev_b32 v13, 1, v2
    v_add_u32 v14, s40, v13
    global_load_ushort v80, v14, s[4:5] offset:0
    global_load_ushort v90, v13, s[26:27] offset:0
    global_load_ushort v81, v14, s[4:5] offset:128
    global_load_ushort v91, v13, s[26:27] offset:128
    global_load_ushort v82, v14, s[4:5] offset:256
    global_load_ushort v92, v13, s[26:27] offset:256
    global_load_ushort v83, v14, s[4:5] offset:384
    global_load_ushort v93, v13, s[26:27] offset:384
    global_load_ushort v84, v14, s[4:5] offset:512
    global_load_ushort v94, v13, s[26:27] offset:512
    global_load_ushort v85, v14, s[4:5] offset:640
    global_load_ushort v95, v13, s[26:27] offset:640
    global_load_ushort v86, v14, s[4:5] offset:768
    global_load_ushort v96, v13, s[26:27] offset:768
    global_load_ushort v87, v14, s[4:5] offset:896
    global_load_ushort v97, v13, s[26:27] offset:896
    global_load_ushort v88, v14, s[4:5] offset:1024
    global_load_ushort v98, v13, s[26:27] offset:1024
    s_lshl_b32 s40, s62, 4
    v_add_u32 v10, s40, v3
    v_lshlrev_b32 v13, 1, v10
    global_load_ushort v36, v13, s[24:25]
    s_waitcnt vmcnt(0)
    v_mov_b32 v37, 0
    v_lshlrev_b32 v80, 16, v80
    v_lshlrev_b32 v90, 16, v90
    v_mul_f32 v80, v80, v90
    v_cvt_pk_bf16_f32 v80, v80, v80
    v_lshlrev_b32 v80, 16, v80
    v_add_f32 v37, v37, v80
    v_lshlrev_b32 v81, 16, v81
    v_lshlrev_b32 v91, 16, v91
    v_mul_f32 v81, v81, v91
    v_cvt_pk_bf16_f32 v81, v81, v81
    v_lshlrev_b32 v81, 16, v81
    v_add_f32 v37, v37, v81
    v_lshlrev_b32 v82, 16, v82
    v_lshlrev_b32 v92, 16, v92
    v_mul_f32 v82, v82, v92
    v_cvt_pk_bf16_f32 v82, v82, v82
    v_lshlrev_b32 v82, 16, v82
    v_add_f32 v37, v37, v82
    v_lshlrev_b32 v83, 16, v83
    v_lshlrev_b32 v93, 16, v93
    v_mul_f32 v83, v83, v93
    v_cvt_pk_bf16_f32 v83, v83, v83
    v_lshlrev_b32 v83, 16, v83
    v_add_f32 v37, v37, v83
    v_lshlrev_b32 v84, 16, v84
    v_lshlrev_b32 v94, 16, v94
    v_mul_f32 v84, v84, v94
    v_cvt_pk_bf16_f32 v84, v84, v84
    v_lshlrev_b32 v84, 16, v84
    v_add_f32 v37, v37, v84
    v_lshlrev_b32 v85, 16, v85
    v_lshlrev_b32 v95, 16, v95
    v_mul_f32 v85, v85, v95
    v_cvt_pk_bf16_f32 v85, v85, v85
    v_lshlrev_b32 v85, 16, v85
    v_add_f32 v37, v37, v85
    v_lshlrev_b32 v86, 16, v86
    v_lshlrev_b32 v96, 16, v96
    v_mul_f32 v86, v86, v96
    v_cvt_pk_bf16_f32 v86, v86, v86
    v_lshlrev_b32 v86, 16, v86
    v_add_f32 v37, v37, v86
    v_lshlrev_b32 v87, 16, v87
    v_lshlrev_b32 v97, 16, v97
    v_mul_f32 v87, v87, v97
    v_cvt_pk_bf16_f32 v87, v87, v87
    v_lshlrev_b32 v87, 16, v87
    v_add_f32 v37, v37, v87
    v_lshlrev_b32 v88, 16, v88
    v_lshlrev_b32 v98, 16, v98
    v_mul_f32 v88, v88, v98
    v_cvt_pk_bf16_f32 v88, v88, v88
    v_lshlrev_b32 v88, 16, v88
    v_add_f32 v37, v37, v88
    s_nop 1
    v_add_f32_dpp v37, v37, v37 quad_perm:[1,0,3,2] row_mask:0xf bank_mask:0xf
    s_nop 1
    v_add_f32_dpp v37, v37, v37 quad_perm:[2,3,0,1] row_mask:0xf bank_mask:0xf
    s_nop 1
    v_add_f32_dpp v37, v37, v37 row_half_mirror row_mask:0xf bank_mask:0xf
    s_nop 1
    v_add_f32_dpp v37, v37, v37 row_mirror row_mask:0xf bank_mask:0xf
    s_nop 0
    v_readlane_b32 s40, v37, 0
    v_readlane_b32 s41, v37, 16
    v_readlane_b32 s42, v37, 32
    v_readlane_b32 s43, v37, 48
    s_nop 1
    v_mov_b32 v37, s40
    v_add_f32 v37, s41, v37
    v_add_f32 v37, s42, v37
    v_add_f32 v37, s43, v37
    v_cvt_pk_bf16_f32 v37, v37, v37
    v_lshlrev_b32 v37, 16, v37
    v_mul_f32 v37, 0xbfb8aa3b, v37
    v_exp_f32 v37, v37
    s_nop 0
    v_add_f32 v37, 1.0, v37
    v_rcp_f32 v37, v37
    s_nop 0
    v_cvt_pk_bf16_f32 v37, v37, v37
    v_lshlrev_b32 v37, 16, v37
    s_mov_b32 s41, 0
L_poll3:
    s_sleep 2
    v_mov_b32 v13, v9
    global_load_dwordx4 v[40:43], v13, s[32:33] sc1
    v_add_u32 v13, 8192, v13
    global_load_dwordx4 v[44:47], v13, s[32:33] sc1
    v_add_u32 v13, 8192, v13
    global_load_dwordx4 v[48:51], v13, s[32:33] sc1
    v_add_u32 v13, 8192, v13
    global_load_dwordx4 v[52:55], v13, s[32:33] sc1
    global_load_dwordx4 v[56:59], v12, s[32:33] sc1
    s_add_u32 s41, s41, 1
    s_waitcnt vmcnt(0)
    s_mov_b64 s[58:59], 0
    v_cmp_ne_u32 vcc, s39, v41
    s_or_b64 s[58:59], s[58:59], vcc
    v_cmp_ne_u32 vcc, s39, v43
    s_or_b64 s[58:59], s[58:59], vcc
    v_cmp_ne_u32 vcc, s39, v45
    s_or_b64 s[58:59], s[58:59], vcc
    v_cmp_ne_u32 vcc, s39, v47
    s_or_b64 s[58:59], s[58:59], vcc
    v_cmp_ne_u32 vcc, s39, v49
    s_or_b64 s[58:59], s[58:59], vcc
    v_cmp_ne_u32 vcc, s39, v51
    s_or_b64 s[58:59], s[58:59], vcc
    v_cmp_ne_u32 vcc, s39, v53
    s_or_b64 s[58:59], s[58:59], vcc
    v_cmp_ne_u32 vcc, s39, v55
    s_or_b64 s[58:59], s[58:59], vcc
    v_cmp_ne_u32 vcc, s39, v57
    s_or_b64 s[58:59], s[58:59], vcc
    v_cmp_ne_u32 vcc, s39, v59
    s_or_b64 s[58:59], s[58:59], vcc
    s_cmp_gt_u32 s41, 32768
    s_cbranch_scc1 L_poll3_done
    s_cmp_lg_u64 s[58:59], 0
    s_cbranch_scc1 L_poll3
L_poll3_done:
    v_cmp_gt_u32 vcc, 16, v8
    s_nop 1
    v_cndmask_b32 v56, 0, v56, vcc
    v_cndmask_b32 v58, 0, v58, vcc
    v_add_f32 v16, v40, v44
    v_add_f32 v17, v42, v46
    v_add_f32 v18, v48, v52
    v_add_f32 v19, v50, v54
    v_add_f32 v18, v18, v56
    v_add_f32 v19, v19, v58
    s_nop 1
    v_add_f32_dpp v16, v16, v16 row_ror:8 row_mask:0xf bank_mask:0xf
    v_add_f32_dpp v17, v17, v17 row_ror:8 row_mask:0xf bank_mask:0xf
    v_add_f32_dpp v18, v18, v18 row_ror:8 row_mask:0xf bank_mask:0xf
    v_add_f32_dpp v19, v19, v19 row_ror:8 row_mask:0xf bank_mask:0xf
    v_mov_b32 v20, v16
    v_mov_b32 v21, v17
    v_mov_b32 v22, v18
    v_mov_b32 v23, v19
    s_nop 1
    v_permlane16_swap_b32 v16, v20
    v_permlane16_swap_b32 v17, v21
    v_permlane16_swap_b32 v18, v22
    v_permlane16_swap_b32 v19, v23
    s_nop 1
    v_add_f32 v16, v16, v20
    v_add_f32 v17, v17, v21
    v_add_f32 v18, v18, v22
    v_add_f32 v19, v19, v23
    v_mov_b32 v20, v16
    v_mov_b32 v21, v17
    v_mov_b32 v22, v18
    v_mov_b32 v23, v19
    s_nop 1
    v_permlane32_swap_b32 v16, v20
    v_permlane32_swap_b32 v17, v21
    v_permlane32_swap_b32 v18, v22
    v_permlane32_swap_b32 v19, v23
    s_nop 1
    v_add_f32 v16, v16, v20
    v_add_f32 v17, v17, v21
    v_add_f32 v18, v18, v22
    v_add_f32 v19, v19, v23
    s_lshl_b32 s40, s34, 7
    s_add_u32 s40, s40, 143360
    v_lshl_add_u32 v13, v2, 3, s40
    s_mov_b64 exec, 0xff
    ds_write_b64 v13, v[16:17]
    ds_write_b64 v13, v[18:19] offset:64
    s_mov_b64 exec, -1
    s_waitcnt lgkmcnt(0)
    s_barrier
    s_cmp_lg_u32 s34, 0
    s_cbranch_scc1 L_fin
    v_lshlrev_b32 v13, 2, v3
    v_add_u32 v13, 143360, v13
    ds_read_b32 v40, v13 offset:0
    ds_read_b32 v48, v13 offset:64
    ds_read_b32 v41, v13 offset:128
    ds_read_b32 v49, v13 offset:192
    ds_read_b32 v42, v13 offset:256
    ds_read_b32 v50, v13 offset:320
    ds_read_b32 v43, v13 offset:384
    ds_read_b32 v51, v13 offset:448
    ds_read_b32 v44, v13 offset:512
    ds_read_b32 v52, v13 offset:576
    ds_read_b32 v45, v13 offset:640
    ds_read_b32 v53, v13 offset:704
    ds_read_b32 v46, v13 offset:768
    ds_read_b32 v54, v13 offset:832
    ds_read_b32 v47, v13 offset:896
    ds_read_b32 v55, v13 offset:960
    s_waitcnt lgkmcnt(0)
    v_add_f32 v40, v40, v44
    v_add_f32 v41, v41, v45
    v_add_f32 v42, v42, v46
    v_add_f32 v43, v43, v47
    v_add_f32 v40, v40, v42
    v_add_f32 v41, v41, v43
    v_add_f32 v40, v40, v41
    v_add_f32 v48, v48, v52
    v_add_f32 v49, v49, v53
    v_add_f32 v50, v50, v54
    v_add_f32 v51, v51, v55
    v_add_f32 v48, v48, v50
    v_add_f32 v49, v49, v51
    v_add_f32 v48, v48, v49
    v_cvt_pk_bf16_f32 v40, v40, v40
    v_lshlrev_b32 v40, 16, v40
    v_cvt_pk_bf16_f32 v41, v48, v48
    v_lshlrev_b32 v41, 16, v41
    v_lshlrev_b32 v36, 16, v36
    v_add_f32 v41, v41, v36
    v_cvt_pk_bf16_f32 v41, v41, v41
    v_lshlrev_b32 v41, 16, v41
    v_mul_f32 v40, v37, v40
    v_cvt_pk_bf16_f32 v40, v40, v40
    v_lshlrev_b32 v40, 16, v40
    v_sub_f32 v37, 1.0, v37
    v_cvt_pk_bf16_f32 v37, v37, v37
    v_lshlrev_b32 v37, 16, v37
    v_mul_f32 v41, v37, v41
    v_cvt_pk_bf16_f32 v41, v41, v41
    v_lshlrev_b32 v41, 16, v41
    v_add_f32 v40, v40, v41
    v_cvt_pk_bf16_f32 v40, v40, v40
    s_mul_i32 s40, s61, 1152
    v_lshlrev_b32 v10, 1, v10
    v_add_u32 v10, s40, v10
    s_mov_b64 exec, 0xffff
    global_store_short v10, v40, s[28:29]
    s_cmp_lg_u32 s2, 0
    s_cbranch_scc1 L_fin0
    s_mov_b64 exec, 1
    v_mov_b32 v10, 0
    v_mov_b32 v11, s39
    global_store_dword v10, v11, s[32:33]
L_fin0:
    s_mov_b64 exec, -1
    s_branch L_fin
L_B:
    s_sub_u32 s63, s2, 128
    s_and_b32 s35, s63, 31
    s_lshr_b32 s36, s63, 5
    s_lshl_b32 s44, s35, 8
    v_mov_b32 v8, 0
    v_mov_b32 v9, 0
    v_lshlrev_b32 v10, 3, v3
    s_mov_b64 exec, 0xff
    ds_write_b64 v10, v[8:9] offset:7680
    s_mov_b64 exec, -1
    s_lshl_b32 s40, s36, 7
    s_lshl_b32 s41, s34, 4
    s_add_u32 s40, s40, s41
    v_add_u32 v5, s40, v3
    v_lshlrev_b32 v5, 13, v5
    v_lshl_add_u32 v5, v4, 4, v5
    v_add_u32 v5, s44, v5
    global_load_dwordx4 v[184:187], v5, s[10:11] offset:0 nt
    global_load_dwordx4 v[188:191], v5, s[10:11] offset:64 nt
    global_load_dwordx4 v[192:195], v5, s[10:11] offset:128 nt
    global_load_dwordx4 v[196:199], v5, s[10:11] offset:192 nt
    s_cmp_ge_u32 s34, 5
    s_cbranch_scc1 L_B_noq
    s_lshl_b32 s47, s34, 2
    s_add_u32 s47, s47, s36
    v_mov_b32 v152, 0
    v_mov_b32 v153, 0
    v_mov_b32 v156, 0
    v_mov_b32 v157, 0
    v_mov_b32 v160, 0
    v_mov_b32 v161, 0
    v_mov_b32 v164, 0
    v_mov_b32 v165, 0
    v_mov_b32 v168, 0
    v_mov_b32 v169, 0
    v_mov_b32 v172, 0
    v_mov_b32 v173, 0
    v_mov_b32 v176, 0
    v_mov_b32 v177, 0
    v_mov_b32 v180, 0
    v_mov_b32 v181, 0
    s_cmp_ge_u32 s47, 18
    s_cbranch_scc1 L_B_qz
    v_and_b32 v6, 1, v3
    v_mul_u32_u24 v6, 1152, v6
    v_lshl_add_u32 v6, v4, 4, v6
    s_lshl_b32 s40, s47, 6
    v_add_u32 v6, s40, v6
    global_load_dwordx4 v[12:15], v6, s[4:5]
    s_lshl_b32 s40, s47, 5
    v_lshl_add_u32 v7, v4, 3, s40
    v_lshlrev_b32 v7, 13, v7
    v_lshl_add_u32 v7, v3, 4, v7
    v_add_u32 v7, s44, v7
    global_load_dwordx4 v[24:27], v7, s[8:9] nt
    v_add_u32 v7, 8192, v7
    global_load_dwordx4 v[28:31], v7, s[8:9] nt
    v_add_u32 v7, 8192, v7
    global_load_dwordx4 v[32:35], v7, s[8:9] nt
    v_add_u32 v7, 8192, v7
    global_load_dwordx4 v[36:39], v7, s[8:9] nt
    v_add_u32 v7, 8192, v7
    global_load_dwordx4 v[40:43], v7, s[8:9] nt
    v_add_u32 v7, 8192, v7
    global_load_dwordx4 v[44:47], v7, s[8:9] nt
    v_add_u32 v7, 8192, v7
    global_load_dwordx4 v[48:51], v7, s[8:9] nt
    v_add_u32 v7, 8192, v7
    global_load_dwordx4 v[52:55], v7, s[8:9] nt
    s_waitcnt vmcnt(0)
    v_perm_b32 v120, v28, v24, s37
    v_perm_b32 v121, v36, v32, s37
    v_perm_b32 v122, v44, v40, s37
    v_perm_b32 v123, v52, v48, s37
    v_perm_b32 v124, v28, v24, s38
    v_perm_b32 v125, v36, v32, s38
    v_perm_b32 v126, v44, v40, s38
    v_perm_b32 v127, v52, v48, s38
    v_perm_b32 v128, v29, v25, s37
    v_perm_b32 v129, v37, v33, s37
    v_perm_b32 v130, v45, v41, s37
    v_perm_b32 v131, v53, v49, s37
    v_perm_b32 v132, v29, v25, s38
    v_perm_b32 v133, v37, v33, s38
    v_perm_b32 v134, v45, v41, s38
    v_perm_b32 v135, v53, v49, s38
    v_perm_b32 v136, v30, v26, s37
    v_perm_b32 v137, v38, v34, s37
    v_perm_b32 v138, v46, v42, s37
    v_perm_b32 v139, v54, v50, s37
    v_perm_b32 v140, v30, v26, s38
    v_perm_b32 v141, v38, v34, s38
    v_perm_b32 v142, v46, v42, s38
    v_perm_b32 v143, v54, v50, s38
    v_perm_b32 v144, v31, v27, s37
    v_perm_b32 v145, v39, v35, s37
    v_perm_b32 v146, v47, v43, s37
    v_perm_b32 v147, v55, v51, s37
    v_perm_b32 v148, v31, v27, s38
    v_perm_b32 v149, v39, v35, s38
    v_perm_b32 v150, v47, v43, s38
    v_perm_b32 v151, v55, v51, s38
    s_nop 1
    v_mfma_f32_16x16x32_bf16 v[152:155], v[12:15], v[120:123], 0
    v_mfma_f32_16x16x32_bf16 v[156:159], v[12:15], v[124:127], 0
    v_mfma_f32_16x16x32_bf16 v[160:163], v[12:15], v[128:131], 0
    v_mfma_f32_16x16x32_bf16 v[164:167], v[12:15], v[132:135], 0
    v_mfma_f32_16x16x32_bf16 v[168:171], v[12:15], v[136:139], 0
    v_mfma_f32_16x16x32_bf16 v[172:175], v[12:15], v[140:143], 0
    v_mfma_f32_16x16x32_bf16 v[176:179], v[12:15], v[144:147], 0
    v_mfma_f32_16x16x32_bf16 v[180:183], v[12:15], v[148:151], 0
    s_nop 7
L_B_qz:
    v_lshlrev_b32 v8, 5, v3
    s_lshl_b32 s40, s34, 10
    v_add_u32 v8, s40, v8
    s_mov_b64 exec, 0xffff
    ds_write_b32 v8, v152 offset:0
    ds_write_b32 v8, v153 offset:512
    ds_write_b32 v8, v156 offset:4
    ds_write_b32 v8, v157 offset:516
    ds_write_b32 v8, v160 offset:8
    ds_write_b32 v8, v161 offset:520
    ds_write_b32 v8, v164 offset:12
    ds_write_b32 v8, v165 offset:524
    ds_write_b32 v8, v168 offset:16
    ds_write_b32 v8, v169 offset:528
    ds_write_b32 v8, v172 offset:20
    ds_write_b32 v8, v173 offset:532
    ds_write_b32 v8, v176 offset:24
    ds_write_b32 v8, v177 offset:536
    ds_write_b32 v8, v180 offset:28
    ds_write_b32 v8, v181 offset:540
    s_mov_b64 exec, -1
L_B_noq:
    s_waitcnt lgkmcnt(0)
    s_mul_i32 s39, s62, 0x9E3779B1
    s_add_u32 s39, s39, 0x7F4A7C15
    s_barrier
    s_cmp_ge_u32 s34, 4
    s_cbranch_scc1 L_B_sk1
    v_lshlrev_b32 v8, 2, v0
    ds_read_b32 v24, v8 offset:0
    ds_read_b32 v25, v8 offset:1024
    ds_read_b32 v26, v8 offset:2048
    ds_read_b32 v27, v8 offset:3072
    ds_read_b32 v28, v8 offset:4096
    s_lshl_b32 s40, s35, 13
    s_add_u32 s40, s40, 589824
    v_lshl_add_u32 v8, v0, 3, s40
    s_lshl_b32 s41, s36, 11
    v_add_u32 v9, s41, v8
    v_add_u32 v10, 4096, v8
    s_waitcnt lgkmcnt(0)
    v_add_f32 v24, v24, v25
    v_add_f32 v24, v24, v26
    v_add_f32 v24, v24, v27
    v_add_f32 v24, v24, v28
    v_mov_b32 v25, s39
    global_store_dwordx2 v9, v[24:25], s[32:33] sc1
    s_mov_b32 s41, 0
L_poll0:
    global_load_dwordx2 v[24:25], v8, s[32:33] sc1
    global_load_dwordx2 v[26:27], v8, s[32:33] offset:2048 sc1
    global_load_dwordx2 v[28:29], v10, s[32:33] sc1
    global_load_dwordx2 v[30:31], v10, s[32:33] offset:2048 sc1
    s_add_u32 s41, s41, 1
    s_waitcnt vmcnt(0)
    s_mov_b64 s[58:59], 0
    v_cmp_ne_u32 vcc, s39, v25
    s_or_b64 s[58:59], s[58:59], vcc
    v_cmp_ne_u32 vcc, s39, v27
    s_or_b64 s[58:59], s[58:59], vcc
    v_cmp_ne_u32 vcc, s39, v29
    s_or_b64 s[58:59], s[58:59], vcc
    v_cmp_ne_u32 vcc, s39, v31
    s_or_b64 s[58:59], s[58:59], vcc
    s_cmp_gt_u32 s41, 32768
    s_cbranch_scc1 L_poll0_done
    s_cmp_lg_u64 s[58:59], 0
    s_cbranch_scc1 L_poll0
L_poll0_done:
    v_add_f32 v24, v24, v26
    v_add_f32 v28, v28, v30
    v_add_f32 v24, v24, v28
    v_cvt_pk_bf16_f32 v24, v24, v24
    v_lshlrev_b32 v8, 1, v0
    ds_write_b16 v8, v24 offset:6144
    s_waitcnt lgkmcnt(0)
L_B_sk1:
    s_barrier
    v_and_b32 v6, 1, v3
    v_lshlrev_b32 v6, 8, v6
    v_lshl_add_u32 v6, v4, 4, v6
    ds_read_b128 v[24:27], v6 offset:6144
    ds_read_b128 v[28:31], v6 offset:6208
    ds_read_b128 v[32:35], v6 offset:6272
    ds_read_b128 v[36:39], v6 offset:6336
    s_waitcnt vmcnt(0) lgkmcnt(0)
    v_mfma_f32_16x16x32_bf16 v[40:43], v[24:27], v[184:187], 0
    v_mfma_f32_16x16x32_bf16 v[40:43], v[28:31], v[188:191], v[40:43]
    v_mfma_f32_16x16x32_bf16 v[40:43], v[32:35], v[192:195], v[40:43]
    v_mfma_f32_16x16x32_bf16 v[40:43], v[36:39], v[196:199], v[40:43]
    s_lshl_b32 s40, s34, 6
    v_lshl_add_u32 v6, v3, 2, s40
    s_nop 7
    v_mov_b32_dpp v44, v40 quad_perm:[1,0,3,2] row_mask:0xf bank_mask:0xf
    v_mov_b32_dpp v46, v41 quad_perm:[1,0,3,2] row_mask:0xf bank_mask:0xf
    v_cvt_pk_bf16_f32 v44, v40, v44
    v_mov_b32 v45, s39
    v_cvt_pk_bf16_f32 v46, v41, v46
    v_mov_b32 v47, s39
    s_mov_b64 exec, 0x5555
    ds_write_b64 v6, v[44:45] offset:6656
    ds_write_b64 v6, v[46:47] offset:7168
    s_mov_b64 exec, -1
    s_waitcnt lgkmcnt(0)
    s_barrier
    s_cmp_lg_u32 s34, 7
    s_cbranch_scc1 L_B_streams
    v_lshlrev_b32 v6, 4, v2
    ds_read_b128 v[44:47], v6 offset:6656
    s_lshl_b32 s40, s36, 9
    s_lshl_b32 s41, s35, 11
    s_add_u32 s40, s40, s41
    s_add_u32 s40, s40, 65536
    v_and_b32 v5, 31, v2
    v_lshlrev_b32 v5, 4, v5
    v_lshrrev_b32 v6, 5, v2
    v_lshl_add_u32 v5, v6, 16, v5
    v_add_u32 v5, s40, v5
    s_waitcnt lgkmcnt(0)
    global_store_dwordx4 v5, v[44:47], s[32:33] sc1
    s_lshl_b32 s41, s35, 4
    s_add_u32 s40, s41, 196608
    v_lshlrev_b32 v8, 9, v2
    v_add_u32 v8, s40, v8
    v_add_u32 v9, 0x8000, v8
    s_mov_b32 s41, 0
L_poll2:
    s_sleep 1
    global_load_dwordx4 v[16:19], v8, s[32:33] sc1
    global_load_dwordx4 v[20:23], v9, s[32:33] sc1
    s_add_u32 s41, s41, 1
    s_waitcnt vmcnt(0)
    s_mov_b64 s[58:59], 0
    v_cmp_ne_u32 vcc, s39, v18
    s_or_b64 s[58:59], s[58:59], vcc
    v_cmp_ne_u32 vcc, s39, v22
    s_or_b64 s[58:59], s[58:59], vcc
    s_cmp_gt_u32 s41, 32768
    s_cbranch_scc1 L_poll2_done
    s_cmp_lg_u64 s[58:59], 0
    s_cbranch_scc1 L_poll2
L_poll2_done:
    s_waitcnt lgkmcnt(0)
    v_mov_b32 v14, 0
    v_mov_b32 v15, 1
    s_mov_b64 exec, 1
    ds_add_u32 v14, v15 offset:7692
    s_mov_b64 exec, -1
    v_mov_b32 v24, v16
    s_nop 1
    v_max_f32_dpp v24, v24, v24 quad_perm:[1,0,3,2] row_mask:0xf bank_mask:0xf
    s_nop 1
    v_max_f32_dpp v24, v24, v24 quad_perm:[2,3,0,1] row_mask:0xf bank_mask:0xf
    s_nop 1
    v_max_f32_dpp v24, v24, v24 row_half_mirror row_mask:0xf bank_mask:0xf
    s_nop 1
    v_max_f32_dpp v24, v24, v24 row_mirror row_mask:0xf bank_mask:0xf
    s_nop 0
    v_readlane_b32 s40, v24, 0
    v_readlane_b32 s41, v24, 16
    v_readlane_b32 s42, v24, 32
    v_readlane_b32 s43, v24, 48
    s_nop 1
    v_mov_b32 v24, s40
    v_max_f32 v24, s41, v24
    v_max_f32 v24, s42, v24
    v_max_f32 v24, s43, v24
    v_sub_f32 v16, v16, v24
    v_mul_f32 v16, 0x3fb8aa3b, v16
    v_exp_f32 v16, v16
    s_nop 0
    v_mul_f32 v24, v16, v17
    s_nop 1
    v_add_f32_dpp v24, v24, v24 quad_perm:[1,0,3,2] row_mask:0xf bank_mask:0xf
    s_nop 1
    v_add_f32_dpp v24, v24, v24 quad_perm:[2,3,0,1] row_mask:0xf bank_mask:0xf
    s_nop 1
    v_add_f32_dpp v24, v24, v24 row_half_mirror row_mask:0xf bank_mask:0xf
    s_nop 1
    v_add_f32_dpp v24, v24, v24 row_mirror row_mask:0xf bank_mask:0xf
    s_nop 0
    v_readlane_b32 s40, v24, 0
    v_readlane_b32 s41, v24, 16
    v_readlane_b32 s42, v24, 32
    v_readlane_b32 s43, v24, 48
    s_nop 1
    v_mov_b32 v24, s40
    v_add_f32 v24, s41, v24
    v_add_f32 v24, s42, v24
    v_add_f32 v24, s43, v24
    v_rcp_f32 v24, v24
    s_nop 0
    v_mul_f32 v16, v16, v24
    v_lshlrev_b32 v10, 2, v2
    ds_write_b32 v10, v16 offset:8448
    v_mov_b32 v24, v20
    s_nop 1
    v_max_f32_dpp v24, v24, v24 quad_perm:[1,0,3,2] row_mask:0xf bank_mask:0xf
    s_nop 1
    v_max_f32_dpp v24, v24, v24 quad_perm:[2,3,0,1] row_mask:0xf bank_mask:0xf
    s_nop 1
    v_max_f32_dpp v24, v24, v24 row_half_mirror row_mask:0xf bank_mask:0xf
    s_nop 1
    v_max_f32_dpp v24, v24, v24 row_mirror row_mask:0xf bank_mask:0xf
    s_nop 0
    v_readlane_b32 s40, v24, 0
    v_readlane_b32 s41, v24, 16
    v_readlane_b32 s42, v24, 32
    v_readlane_b32 s43, v24, 48
    s_nop 1
    v_mov_b32 v24, s40
    v_max_f32 v24, s41, v24
    v_max_f32 v24, s42, v24
    v_max_f32 v24, s43, v24
    v_sub_f32 v20, v20, v24
    v_mul_f32 v20, 0x3fb8aa3b, v20
    v_exp_f32 v20, v20
    s_nop 0
    v_mul_f32 v24, v20, v21
    s_nop 1
    v_add_f32_dpp v24, v24, v24 quad_perm:[1,0,3,2] row_mask:0xf bank_mask:0xf
    s_nop 1
    v_add_f32_dpp v24, v24, v24 quad_perm:[2,3,0,1] row_mask:0xf bank_mask:0xf
    s_nop 1
    v_add_f32_dpp v24, v24, v24 row_half_mirror row_mask:0xf bank_mask:0xf
    s_nop 1
    v_add_f32_dpp v24, v24, v24 row_mirror row_mask:0xf bank_mask:0xf
    s_nop 0
    v_readlane_b32 s40, v24, 0
    v_readlane_b32 s41, v24, 16
    v_readlane_b32 s42, v24, 32
    v_readlane_b32 s43, v24, 48
    s_nop 1
    v_mov_b32 v24, s40
    v_add_f32 v24, s41, v24
    v_add_f32 v24, s42, v24
    v_add_f32 v24, s43, v24
    v_rcp_f32 v24, v24
    s_nop 0
    v_mul_f32 v20, v20, v24
    v_lshlrev_b32 v10, 2, v2
    ds_write_b32 v10, v20 offset:8704
    s_waitcnt lgkmcnt(0)
    v_mov_b32 v14, 0
    v_mov_b32 v15, 1
    s_mov_b64 exec, 1
    ds_add_u32 v14, v15 offset:7680
    s_mov_b64 exec, -1
    s_branch L_fin
L_B_streams:
    s_cmp_eq_u32 s34, 6
    s_cbranch_scc1 L_B_w6
    s_mul_i32 s48, s63, 6
    s_add_u32 s48, s48, s34
    s_cmp_ge_u32 s48, 648
    s_cbranch_scc1 L_B_noffn1
    s_mul_i32 s41, s48, 1821
    s_lshr_b32 s49, s41, 16
    s_mul_i32 s41, s49, 36
    s_sub_u32 s50, s48, s41
    v_and_b32 v6, 1, v3
    v_mul_u32_u24 v6, 1152, v6
    v_lshl_add_u32 v6, v4, 4, v6
    s_lshl_b32 s40, s49, 6
    v_add_u32 v6, s40, v6
    global_load_dwordx4 v[12:15], v6, s[4:5]
    s_lshl_b32 s40, s49, 5
    v_lshl_add_u32 v7, v4, 3, s40
    v_mul_u32_u24 v7, 9216, v7
    v_lshl_add_u32 v7, v3, 4, v7
    s_lshl_b32 s40, s50, 8
    v_add_u32 v7, s40, v7
    global_load_dwordx4 v[24:27], v7, s[18:19] nt
    v_add_u32 v7, 9216, v7
    global_load_dwordx4 v[28:31], v7, s[18:19] nt
    v_add_u32 v7, 9216, v7
    global_load_dwordx4 v[32:35], v7, s[18:19] nt
    v_add_u32 v7, 9216, v7
    global_load_dwordx4 v[36:39], v7, s[18:19] nt
    v_add_u32 v7, 9216, v7
    global_load_dwordx4 v[40:43], v7, s[18:19] nt
    v_add_u32 v7, 9216, v7
    global_load_dwordx4 v[44:47], v7, s[18:19] nt
    v_add_u32 v7, 9216, v7
    global_load_dwordx4 v[48:51], v7, s[18:19] nt
    v_add_u32 v7, 9216, v7
    global_load_dwordx4 v[52:55], v7, s[18:19] nt
L_B_noffn1:
    s_cmp_ge_u32 s48, 648
    s_cbranch_scc1 L_B_noffn1b
    s_waitcnt vmcnt(0)
    v_perm_b32 v56, v28, v24, s37
    v_perm_b32 v57, v36, v32, s37
    v_perm_b32 v58, v44, v40, s37
    v_perm_b32 v59, v52, v48, s37
    v_perm_b32 v60, v28, v24, s38
    v_perm_b32 v61, v36, v32, s38
    v_perm_b32 v62, v44, v40, s38
    v_perm_b32 v63, v52, v48, s38
    v_perm_b32 v64, v29, v25, s37
    v_perm_b32 v65, v37, v33, s37
    v_perm_b32 v66, v45, v41, s37
    v_perm_b32 v67, v53, v49, s37
    v_perm_b32 v68, v29, v25, s38
    v_perm_b32 v69, v37, v33, s38
    v_perm_b32 v70, v45, v41, s38
    v_perm_b32 v71, v53, v49, s38
    v_perm_b32 v72, v30, v26, s37
    v_perm_b32 v73, v38, v34, s37
    v_perm_b32 v74, v46, v42, s37
    v_perm_b32 v75, v54, v50, s37
    v_perm_b32 v76, v30, v26, s38
    v_perm_b32 v77, v38, v34, s38
    v_perm_b32 v78, v46, v42, s38
    v_perm_b32 v79, v54, v50, s38
    v_perm_b32 v80, v31, v27, s37
    v_perm_b32 v81, v39, v35, s37
    v_perm_b32 v82, v47, v43, s37
    v_perm_b32 v83, v55, v51, s37
    v_perm_b32 v84, v31, v27, s38
    v_perm_b32 v85, v39, v35, s38
    v_perm_b32 v86, v47, v43, s38
    v_perm_b32 v87, v55, v51, s38
    s_nop 1
    v_mfma_f32_16x16x32_bf16 v[88:91], v[12:15], v[56:59], 0
    v_mfma_f32_16x16x32_bf16 v[92:95], v[12:15], v[60:63], 0
    v_mfma_f32_16x16x32_bf16 v[96:99], v[12:15], v[64:67], 0
    v_mfma_f32_16x16x32_bf16 v[100:103], v[12:15], v[68:71], 0
    v_mfma_f32_16x16x32_bf16 v[104:107], v[12:15], v[72:75], 0
    v_mfma_f32_16x16x32_bf16 v[108:111], v[12:15], v[76:79], 0
    v_mfma_f32_16x16x32_bf16 v[112:115], v[12:15], v[80:83], 0
    v_mfma_f32_16x16x32_bf16 v[116:119], v[12:15], v[84:87], 0
    s_mul_i32 s40, s49, 73728
    s_lshl_b32 s41, s50, 10
    s_add_u32 s40, s40, s41
    s_add_u32 s40, s40, 1376256
    v_lshl_add_u32 v8, v2, 4, s40
    s_nop 7
    v_mov_b32 v24, v88
    v_mov_b32 v25, s39
    v_mov_b32 v26, v92
    v_mov_b32 v27, s39
    v_mov_b32 v28, v96
    v_mov_b32 v29, s39
    v_mov_b32 v30, v100
    v_mov_b32 v31, s39
    v_mov_b32 v32, v104
    v_mov_b32 v33, s39
    v_mov_b32 v34, v108
    v_mov_b32 v35, s39
    v_mov_b32 v36, v112
    v_mov_b32 v37, s39
    v_mov_b32 v38, v116
    v_mov_b32 v39, s39
    v_mov_b32 v40, v89
    v_mov_b32 v41, s39
    v_mov_b32 v42, v93
    v_mov_b32 v43, s39
    v_mov_b32 v44, v97
    v_mov_b32 v45, s39
    v_mov_b32 v46, v101
    v_mov_b32 v47, s39
    v_mov_b32 v48, v105
    v_mov_b32 v49, s39
    v_mov_b32 v50, v109
    v_mov_b32 v51, s39
    v_mov_b32 v52, v113
    v_mov_b32 v53, s39
    v_mov_b32 v54, v117
    v_mov_b32 v55, s39
    s_lshl_b32 s42, s34, 11
    s_add_u32 s42, s42, 16384
    v_lshl_add_u32 v9, v3, 6, s42
    s_mov_b64 exec, 0xffff
    ds_write_b128 v9, v[24:27] offset:0
    ds_write_b128 v9, v[28:31] offset:16
    ds_write_b128 v9, v[32:35] offset:32
    ds_write_b128 v9, v[36:39] offset:48
    ds_write_b128 v9, v[40:43] offset:1024
    ds_write_b128 v9, v[44:47] offset:1040
    ds_write_b128 v9, v[48:51] offset:1056
    ds_write_b128 v9, v[52:55] offset:1072
    s_mov_b64 exec, -1
    v_lshl_add_u32 v9, v2, 4, s42
    s_waitcnt lgkmcnt(0)
    ds_read_b128 v[24:27], v9
    ds_read_b128 v[28:31], v9 offset:1024
    v_add_u32 v9, 36864, v8
    s_waitcnt lgkmcnt(1)
    global_store_dwordx4 v8, v[24:27], s[32:33] sc1
    s_waitcnt lgkmcnt(0)
    global_store_dwordx4 v9, v[28:31], s[32:33] sc1
L_B_noffn1b:
    s_min_u32 s45, s34, 4
    s_cmp_eq_u32 s45, 4
    s_cselect_b32 s40, 7, 15
    v_and_b32 v8, s40, v3
    v_lshlrev_b32 v8, 4, v8
    s_lshl_b32 s40, s45, 8
    v_add_u32 v8, s40, v8
    s_lshl_b32 s40, s35, 7
    v_lshl_add_u32 v7, v4, 3, s40
    v_mul_u32_u24 v7, 1152, v7
    v_add_u32 v7, v7, v8
    s_cmp_eq_u32 s34, 5
    s_cbranch_scc1 L_B_noo
    v_add_u32 v8, 0, v7
    global_load_dwordx4 v[96:99], v8, s[14:15] offset:0
    global_load_dwordx4 v[100:103], v8, s[14:15] offset:1152
    global_load_dwordx4 v[104:107], v8, s[14:15] offset:2304
    v_add_u32 v8, 3456, v8
    global_load_dwordx4 v[108:111], v8, s[14:15] offset:0
    global_load_dwordx4 v[112:115], v8, s[14:15] offset:1152
    global_load_dwordx4 v[116:119], v8, s[14:15] offset:2304
    v_add_u32 v8, 3456, v8
    global_load_dwordx4 v[120:123], v8, s[14:15] offset:0
    global_load_dwordx4 v[124:127], v8, s[14:15] offset:1152
    v_add_u32 v8, 36864, v7
    global_load_dwordx4 v[128:131], v8, s[14:15] offset:0
    global_load_dwordx4 v[132:135], v8, s[14:15] offset:1152
    global_load_dwordx4 v[136:139], v8, s[14:15] offset:2304
    v_add_u32 v8, 3456, v8
    global_load_dwordx4 v[140:143], v8, s[14:15] offset:0
    global_load_dwordx4 v[144:147], v8, s[14:15] offset:1152
    global_load_dwordx4 v[148:151], v8, s[14:15] offset:2304
    v_add_u32 v8, 3456, v8
    global_load_dwordx4 v[152:155], v8, s[14:15] offset:0
    global_load_dwordx4 v[156:159], v8, s[14:15] offset:1152
    v_add_u32 v8, 73728, v7
    global_load_dwordx4 v[160:163], v8, s[14:15] offset:0
    global_load_dwordx4 v[164:167], v8, s[14:15] offset:1152
    global_load_dwordx4 v[168:171], v8, s[14:15] offset:2304
    v_add_u32 v8, 3456, v8
    global_load_dwordx4 v[172:175], v8, s[14:15] offset:0
    global_load_dwordx4 v[176:179], v8, s[14:15] offset:1152
    global_load_dwordx4 v[180:183], v8, s[14:15] offset:2304
    v_add_u32 v8, 3456, v8
    global_load_dwordx4 v[184:187], v8, s[14:15] offset:0
    global_load_dwordx4 v[188:191], v8, s[14:15] offset:1152
    v_add_u32 v8, 110592, v7
    global_load_dwordx4 v[192:195], v8, s[14:15] offset:0
    global_load_dwordx4 v[196:199], v8, s[14:15] offset:1152
    global_load_dwordx4 v[200:203], v8, s[14:15] offset:2304
    v_add_u32 v8, 3456, v8
    global_load_dwordx4 v[204:207], v8, s[14:15] offset:0
    global_load_dwordx4 v[208:211], v8, s[14:15] offset:1152
    global_load_dwordx4 v[212:215], v8, s[14:15] offset:2304
    v_add_u32 v8, 3456, v8
    global_load_dwordx4 v[216:219], v8, s[14:15] offset:0
    global_load_dwordx4 v[220:223], v8, s[14:15] offset:1152
L_B_noo:
    s_waitcnt vmcnt(0)
    v_perm_b32 v64, v100, v96, s37
    v_perm_b32 v65, v108, v104, s37
    v_perm_b32 v66, v116, v112, s37
    v_perm_b32 v67, v124, v120, s37
    v_perm_b32 v68, v100, v96, s38
    v_perm_b32 v69, v108, v104, s38
    v_perm_b32 v70, v116, v112, s38
    v_perm_b32 v71, v124, v120, s38
    v_perm_b32 v72, v101, v97, s37
    v_perm_b32 v73, v109, v105, s37
    v_perm_b32 v74, v117, v113, s37
    v_perm_b32 v75, v125, v121, s37
    v_perm_b32 v76, v101, v97, s38
    v_perm_b32 v77, v109, v105, s38
    v_perm_b32 v78, v117, v113, s38
    v_perm_b32 v79, v125, v121, s38
    v_perm_b32 v80, v102, v98, s37
    v_perm_b32 v81, v110, v106, s37
    v_perm_b32 v82, v118, v114, s37
    v_perm_b32 v83, v126, v122, s37
    v_perm_b32 v84, v102, v98, s38
    v_perm_b32 v85, v110, v106, s38
    v_perm_b32 v86, v118, v114, s38
    v_perm_b32 v87, v126, v122, s38
    v_perm_b32 v88, v103, v99, s37
    v_perm_b32 v89, v111, v107, s37
    v_perm_b32 v90, v119, v115, s37
    v_perm_b32 v91, v127, v123, s37
    v_perm_b32 v92, v103, v99, s38
    v_perm_b32 v93, v111, v107, s38
    v_perm_b32 v94, v119, v115, s38
    v_perm_b32 v95, v127, v123, s38
    v_perm_b32 v96, v132, v128, s37
    v_perm_b32 v97, v140, v136, s37
    v_perm_b32 v98, v148, v144, s37
    v_perm_b32 v99, v156, v152, s37
    v_perm_b32 v100, v132, v128, s38
    v_perm_b32 v101, v140, v136, s38
    v_perm_b32 v102, v148, v144, s38
    v_perm_b32 v103, v156, v152, s38
    v_perm_b32 v104, v133, v129, s37
    v_perm_b32 v105, v141, v137, s37
    v_perm_b32 v106, v149, v145, s37
    v_perm_b32 v107, v157, v153, s37
    v_perm_b32 v108, v133, v129, s38
    v_perm_b32 v109, v141, v137, s38
    v_perm_b32 v110, v149, v145, s38
    v_perm_b32 v111, v157, v153, s38
    v_perm_b32 v112, v134, v130, s37
    v_perm_b32 v113, v142, v138, s37
    v_perm_b32 v114, v150, v146, s37
    v_perm_b32 v115, v158, v154, s37
    v_perm_b32 v116, v134, v130, s38
    v_perm_b32 v117, v142, v138, s38
    v_perm_b32 v118, v150, v146, s38
    v_perm_b32 v119, v158, v154, s38
    v_perm_b32 v120, v135, v131, s37
    v_perm_b32 v121, v143, v139, s37
    v_perm_b32 v122, v151, v147, s37
    v_perm_b32 v123, v159, v155, s37
    v_perm_b32 v124, v135, v131, s38
    v_perm_b32 v125, v143, v139, s38
    v_perm_b32 v126, v151, v147, s38
    v_perm_b32 v127, v159, v155, s38
    v_perm_b32 v128, v164, v160, s37
    v_perm_b32 v129, v172, v168, s37
    v_perm_b32 v130, v180, v176, s37
    v_perm_b32 v131, v188, v184, s37
    v_perm_b32 v132, v164, v160, s38
    v_perm_b32 v133, v172, v168, s38
    v_perm_b32 v134, v180, v176, s38
    v_perm_b32 v135, v188, v184, s38
    v_perm_b32 v136, v165, v161, s37
    v_perm_b32 v137, v173, v169, s37
    v_perm_b32 v138, v181, v177, s37
    v_perm_b32 v139, v189, v185, s37
    v_perm_b32 v140, v165, v161, s38
    v_perm_b32 v141, v173, v169, s38
    v_perm_b32 v142, v181, v177, s38
    v_perm_b32 v143, v189, v185, s38
    v_perm_b32 v144, v166, v162, s37
    v_perm_b32 v145, v174, v170, s37
    v_perm_b32 v146, v182, v178, s37
    v_perm_b32 v147, v190, v186, s37
    v_perm_b32 v148, v166, v162, s38
    v_perm_b32 v149, v174, v170, s38
    v_perm_b32 v150, v182, v178, s38
    v_perm_b32 v151, v190, v186, s38
    v_perm_b32 v152, v167, v163, s37
    v_perm_b32 v153, v175, v171, s37
    v_perm_b32 v154, v183, v179, s37
    v_perm_b32 v155, v191, v187, s37
    v_perm_b32 v156, v167, v163, s38
    v_perm_b32 v157, v175, v171, s38
    v_perm_b32 v158, v183, v179, s38
    v_perm_b32 v159, v191, v187, s38
    v_perm_b32 v160, v196, v192, s37
    v_perm_b32 v161, v204, v200, s37
    v_perm_b32 v162, v212, v208, s37
    v_perm_b32 v163, v220, v216, s37
    v_perm_b32 v164, v196, v192, s38
    v_perm_b32 v165, v204, v200, s38
    v_perm_b32 v166, v212, v208, s38
    v_perm_b32 v167, v220, v216, s38
    v_perm_b32 v168, v197, v193, s37
    v_perm_b32 v169, v205, v201, s37
    v_perm_b32 v170, v213, v209, s37
    v_perm_b32 v171, v221, v217, s37
    v_perm_b32 v172, v197, v193, s38
    v_perm_b32 v173, v205, v201, s38
    v_perm_b32 v174, v213, v209, s38
    v_perm_b32 v175, v221, v217, s38
    v_perm_b32 v176, v198, v194, s37
    v_perm_b32 v177, v206, v202, s37
    v_perm_b32 v178, v214, v210, s37
    v_perm_b32 v179, v222, v218, s37
    v_perm_b32 v180, v198, v194, s38
    v_perm_b32 v181, v206, v202, s38
    v_perm_b32 v182, v214, v210, s38
    v_perm_b32 v183, v222, v218, s38
    v_perm_b32 v184, v199, v195, s37
    v_perm_b32 v185, v207, v203, s37
    v_perm_b32 v186, v215, v211, s37
    v_perm_b32 v187, v223, v219, s37
    v_perm_b32 v188, v199, v195, s38
    v_perm_b32 v189, v207, v203, s38
    v_perm_b32 v190, v215, v211, s38
    v_perm_b32 v191, v223, v219, s38
    s_cmp_ge_u32 s34, 4
    s_cbranch_scc1 L_B_nocomb
    s_lshl_b32 s40, s34, 5
    v_add_u32 v11, s40, v4
    v_lshlrev_b32 v9, 8, v11
    v_lshl_add_u32 v9, v3, 4, v9
    s_lshl_b32 s40, s35, 17
    s_lshl_b32 s41, s36, 15
    s_add_u32 s40, s40, s41
    s_add_u32 s40, s40, 8388608
    v_add_u32 v9, s40, v9
    v_lshlrev_b32 v10, 2, v11
    v_mov_b32 v24, 0
    v_mov_b32 v25, 0
    v_mov_b32 v26, 0
    v_mov_b32 v27, 0
    v_mov_b32 v28, 0
    v_mov_b32 v29, 0
    v_mov_b32 v30, 0
    v_mov_b32 v31, 0
    v_mov_b32 v14, 0
    s_mov_b32 s41, 0
L_wf0:
    s_sleep 1
    ds_read_b32 v15, v14 offset:7692
    s_add_u32 s41, s41, 1
    s_waitcnt lgkmcnt(0)
    v_cmp_gt_u32 vcc, 1, v15
    s_cmp_gt_u32 s41, 1048576
    s_cbranch_scc1 L_wf0_done
    s_cbranch_vccnz L_wf0
L_wf0_done:
    global_load_dwordx4 v[32:35], v9, s[32:33] offset:0 sc1
    global_load_dwordx4 v[36:39], v9, s[32:33] offset:1024 sc1
    global_load_dwordx4 v[40:43], v9, s[32:33] offset:2048 sc1
    global_load_dwordx4 v[44:47], v9, s[32:33] offset:3072 sc1
    v_add_u32 v9, 4096, v9
    global_load_dwordx4 v[48:51], v9, s[32:33] offset:0 sc1
    global_load_dwordx4 v[52:55], v9, s[32:33] offset:1024 sc1
    global_load_dwordx4 v[56:59], v9, s[32:33] offset:2048 sc1
    global_load_dwordx4 v[60:63], v9, s[32:33] offset:3072 sc1
    v_mov_b32 v14, 0
    s_mov_b32 s41, 0
L_wf1:
    ds_read_b32 v15, v14 offset:7680
    s_add_u32 s41, s41, 1
    s_waitcnt lgkmcnt(0)
    v_cmp_gt_u32 vcc, 1, v15
    s_cmp_gt_u32 s41, 1048576
    s_cbranch_scc1 L_wf1_done
    s_cbranch_vccnz L_wf1
L_wf1_done:
    ds_read_b32 v16, v10 offset:8448
    ds_read_b32 v17, v10 offset:8464
    ds_read_b32 v18, v10 offset:8480
    ds_read_b32 v19, v10 offset:8496
    ds_read_b32 v20, v10 offset:8512
    ds_read_b32 v21, v10 offset:8528
    ds_read_b32 v22, v10 offset:8544
    ds_read_b32 v23, v10 offset:8560
    s_waitcnt vmcnt(7) lgkmcnt(0)
    v_lshlrev_b32 v12, 16, v32
    v_and_b32 v13, 0xffff0000, v32
    v_fmac_f32 v24, v12, v16
    v_fmac_f32 v25, v13, v16
    v_lshlrev_b32 v12, 16, v33
    v_and_b32 v13, 0xffff0000, v33
    v_fmac_f32 v26, v12, v16
    v_fmac_f32 v27, v13, v16
    v_lshlrev_b32 v12, 16, v34
    v_and_b32 v13, 0xffff0000, v34
    v_fmac_f32 v28, v12, v16
    v_fmac_f32 v29, v13, v16
    v_lshlrev_b32 v12, 16, v35
    v_and_b32 v13, 0xffff0000, v35
    v_fmac_f32 v30, v12, v16
    v_fmac_f32 v31, v13, v16
    s_waitcnt vmcnt(6) lgkmcnt(0)
    v_lshlrev_b32 v12, 16, v36
    v_and_b32 v13, 0xffff0000, v36
    v_fmac_f32 v24, v12, v17
    v_fmac_f32 v25, v13, v17
    v_lshlrev_b32 v12, 16, v37
    v_and_b32 v13, 0xffff0000, v37
    v_fmac_f32 v26, v12, v17
    v_fmac_f32 v27, v13, v17
    v_lshlrev_b32 v12, 16, v38
    v_and_b32 v13, 0xffff0000, v38
    v_fmac_f32 v28, v12, v17
    v_fmac_f32 v29, v13, v17
    v_lshlrev_b32 v12, 16, v39
    v_and_b32 v13, 0xffff0000, v39
    v_fmac_f32 v30, v12, v17
    v_fmac_f32 v31, v13, v17
    s_waitcnt vmcnt(5) lgkmcnt(0)
    v_lshlrev_b32 v12, 16, v40
    v_and_b32 v13, 0xffff0000, v40
    v_fmac_f32 v24, v12, v18
    v_fmac_f32 v25, v13, v18
    v_lshlrev_b32 v12, 16, v41
    v_and_b32 v13, 0xffff0000, v41
    v_fmac_f32 v26, v12, v18
    v_fmac_f32 v27, v13, v18
    v_lshlrev_b32 v12, 16, v42
    v_and_b32 v13, 0xffff0000, v42
    v_fmac_f32 v28, v12, v18
    v_fmac_f32 v29, v13, v18
    v_lshlrev_b32 v12, 16, v43
    v_and_b32 v13, 0xffff0000, v43
    v_fmac_f32 v30, v12, v18
    v_fmac_f32 v31, v13, v18
    s_waitcnt vmcnt(4) lgkmcnt(0)
    v_lshlrev_b32 v12, 16, v44
    v_and_b32 v13, 0xffff0000, v44
    v_fmac_f32 v24, v12, v19
    v_fmac_f32 v25, v13, v19
    v_lshlrev_b32 v12, 16, v45
    v_and_b32 v13, 0xffff0000, v45
    v_fmac_f32 v26, v12, v19
    v_fmac_f32 v27, v13, v19
    v_lshlrev_b32 v12, 16, v46
    v_and_b32 v13, 0xffff0000, v46
    v_fmac_f32 v28, v12, v19
    v_fmac_f32 v29, v13, v19
    v_lshlrev_b32 v12, 16, v47
    v_and_b32 v13, 0xffff0000, v47
    v_fmac_f32 v30, v12, v19
    v_fmac_f32 v31, v13, v19
    s_waitcnt vmcnt(3) lgkmcnt(0)
    v_lshlrev_b32 v12, 16, v48
    v_and_b32 v13, 0xffff0000, v48
    v_fmac_f32 v24, v12, v20
    v_fmac_f32 v25, v13, v20
    v_lshlrev_b32 v12, 16, v49
    v_and_b32 v13, 0xffff0000, v49
    v_fmac_f32 v26, v12, v20
    v_fmac_f32 v27, v13, v20
    v_lshlrev_b32 v12, 16, v50
    v_and_b32 v13, 0xffff0000, v50
    v_fmac_f32 v28, v12, v20
    v_fmac_f32 v29, v13, v20
    v_lshlrev_b32 v12, 16, v51
    v_and_b32 v13, 0xffff0000, v51
    v_fmac_f32 v30, v12, v20
    v_fmac_f32 v31, v13, v20
    s_waitcnt vmcnt(2) lgkmcnt(0)
    v_lshlrev_b32 v12, 16, v52
    v_and_b32 v13, 0xffff0000, v52
    v_fmac_f32 v24, v12, v21
    v_fmac_f32 v25, v13, v21
    v_lshlrev_b32 v12, 16, v53
    v_and_b32 v13, 0xffff0000, v53
    v_fmac_f32 v26, v12, v21
    v_fmac_f32 v27, v13, v21
    v_lshlrev_b32 v12, 16, v54
    v_and_b32 v13, 0xffff0000, v54
    v_fmac_f32 v28, v12, v21
    v_fmac_f32 v29, v13, v21
    v_lshlrev_b32 v12, 16, v55
    v_and_b32 v13, 0xffff0000, v55
    v_fmac_f32 v30, v12, v21
    v_fmac_f32 v31, v13, v21
    s_waitcnt vmcnt(1) lgkmcnt(0)
    v_lshlrev_b32 v12, 16, v56
    v_and_b32 v13, 0xffff0000, v56
    v_fmac_f32 v24, v12, v22
    v_fmac_f32 v25, v13, v22
    v_lshlrev_b32 v12, 16, v57
    v_and_b32 v13, 0xffff0000, v57
    v_fmac_f32 v26, v12, v22
    v_fmac_f32 v27, v13, v22
    v_lshlrev_b32 v12, 16, v58
    v_and_b32 v13, 0xffff0000, v58
    v_fmac_f32 v28, v12, v22
    v_fmac_f32 v29, v13, v22
    v_lshlrev_b32 v12, 16, v59
    v_and_b32 v13, 0xffff0000, v59
    v_fmac_f32 v30, v12, v22
    v_fmac_f32 v31, v13, v22
    s_waitcnt vmcnt(0) lgkmcnt(0)
    v_lshlrev_b32 v12, 16, v60
    v_and_b32 v13, 0xffff0000, v60
    v_fmac_f32 v24, v12, v23
    v_fmac_f32 v25, v13, v23
    v_lshlrev_b32 v12, 16, v61
    v_and_b32 v13, 0xffff0000, v61
    v_fmac_f32 v26, v12, v23
    v_fmac_f32 v27, v13, v23
    v_lshlrev_b32 v12, 16, v62
    v_and_b32 v13, 0xffff0000, v62
    v_fmac_f32 v28, v12, v23
    v_fmac_f32 v29, v13, v23
    v_lshlrev_b32 v12, 16, v63
    v_and_b32 v13, 0xffff0000, v63
    v_fmac_f32 v30, v12, v23
    v_fmac_f32 v31, v13, v23
    v_mov_b32 v32, v24
    v_mov_b32 v33, v25
    v_mov_b32 v34, v26
    v_mov_b32 v35, v27
    v_mov_b32 v36, v28
    v_mov_b32 v37, v29
    v_mov_b32 v38, v30
    v_mov_b32 v39, v31
    s_nop 1
    v_permlane16_swap_b32 v24, v32
    v_permlane16_swap_b32 v25, v33
    v_permlane16_swap_b32 v26, v34
    v_permlane16_swap_b32 v27, v35
    v_permlane16_swap_b32 v28, v36
    v_permlane16_swap_b32 v29, v37
    v_permlane16_swap_b32 v30, v38
    v_permlane16_swap_b32 v31, v39
    s_nop 1
    v_add_f32 v24, v24, v32
    v_add_f32 v25, v25, v33
    v_add_f32 v26, v26, v34
    v_add_f32 v27, v27, v35
    v_add_f32 v28, v28, v36
    v_add_f32 v29, v29, v37
    v_add_f32 v30, v30, v38
    v_add_f32 v31, v31, v39
    v_mov_b32 v32, v24
    v_mov_b32 v33, v25
    v_mov_b32 v34, v26
    v_mov_b32 v35, v27
    v_mov_b32 v36, v28
    v_mov_b32 v37, v29
    v_mov_b32 v38, v30
    v_mov_b32 v39, v31
    s_nop 1
    v_permlane32_swap_b32 v24, v32
    v_permlane32_swap_b32 v25, v33
    v_permlane32_swap_b32 v26, v34
    v_permlane32_swap_b32 v27, v35
    v_permlane32_swap_b32 v28, v36
    v_permlane32_swap_b32 v29, v37
    v_permlane32_swap_b32 v30, v38
    v_permlane32_swap_b32 v31, v39
    s_nop 1
    v_add_f32 v24, v24, v32
    v_add_f32 v25, v25, v33
    v_add_f32 v26, v26, v34
    v_add_f32 v27, v27, v35
    v_add_f32 v28, v28, v36
    v_add_f32 v29, v29, v37
    v_add_f32 v30, v30, v38
    v_add_f32 v31, v31, v39
    s_lshl_b32 s40, s34, 9
    v_lshl_add_u32 v10, v2, 5, s40
    s_mov_b64 exec, 0xffff
    ds_write_b128 v10, v[24:27] offset:9216
    ds_write_b128 v10, v[28:31] offset:9232
    s_mov_b64 exec, -1
    s_waitcnt lgkmcnt(0)
    v_mov_b32 v14, 0
    v_mov_b32 v15, 1
    s_mov_b64 exec, 1
    ds_add_u32 v14, v15 offset:7684
    s_mov_b64 exec, -1
L_B_nocomb:
    s_cmp_eq_u32 s34, 5
    s_cbranch_scc1 L_fin
    v_mov_b32 v14, 0
    s_mov_b32 s41, 0
L_wf3:
    ds_read_b32 v15, v14 offset:7688
    s_add_u32 s41, s41, 1
    s_waitcnt lgkmcnt(0)
    v_cmp_gt_u32 vcc, 1, v15
    s_cmp_gt_u32 s41, 1048576
    s_cbranch_scc1 L_wf3_done
    s_cbranch_vccnz L_wf3
L_wf3_done:
    v_and_b32 v5, 1, v3
    v_lshlrev_b32 v5, 8, v5
    v_lshl_add_u32 v5, v4, 4, v5
    ds_read_b128 v[8:11], v5 offset:13312
    ds_read_b128 v[12:15], v5 offset:13376
    ds_read_b128 v[16:19], v5 offset:13440
    ds_read_b128 v[20:23], v5 offset:13504
    s_waitcnt lgkmcnt(0)
    v_mfma_f32_16x16x32_bf16 v[24:27], v[8:11], v[64:67], 0
    v_mfma_f32_16x16x32_bf16 v[28:31], v[8:11], v[68:71], 0
    v_mfma_f32_16x16x32_bf16 v[32:35], v[8:11], v[72:75], 0
    v_mfma_f32_16x16x32_bf16 v[36:39], v[8:11], v[76:79], 0
    v_mfma_f32_16x16x32_bf16 v[40:43], v[8:11], v[80:83], 0
    v_mfma_f32_16x16x32_bf16 v[44:47], v[8:11], v[84:87], 0
    v_mfma_f32_16x16x32_bf16 v[48:51], v[8:11], v[88:91], 0
    v_mfma_f32_16x16x32_bf16 v[52:55], v[8:11], v[92:95], 0
    v_mfma_f32_16x16x32_bf16 v[24:27], v[12:15], v[96:99], v[24:27]
    v_mfma_f32_16x16x32_bf16 v[28:31], v[12:15], v[100:103], v[28:31]
    v_mfma_f32_16x16x32_bf16 v[32:35], v[12:15], v[104:107], v[32:35]
    v_mfma_f32_16x16x32_bf16 v[36:39], v[12:15], v[108:111], v[36:39]
    v_mfma_f32_16x16x32_bf16 v[40:43], v[12:15], v[112:115], v[40:43]
    v_mfma_f32_16x16x32_bf16 v[44:47], v[12:15], v[116:119], v[44:47]
    v_mfma_f32_16x16x32_bf16 v[48:51], v[12:15], v[120:123], v[48:51]
    v_mfma_f32_16x16x32_bf16 v[52:55], v[12:15], v[124:127], v[52:55]
    v_mfma_f32_16x16x32_bf16 v[24:27], v[16:19], v[128:131], v[24:27]
    v_mfma_f32_16x16x32_bf16 v[28:31], v[16:19], v[132:135], v[28:31]
    v_mfma_f32_16x16x32_bf16 v[32:35], v[16:19], v[136:139], v[32:35]
    v_mfma_f32_16x16x32_bf16 v[36:39], v[16:19], v[140:143], v[36:39]
    v_mfma_f32_16x16x32_bf16 v[40:43], v[16:19], v[144:147], v[40:43]
    v_mfma_f32_16x16x32_bf16 v[44:47], v[16:19], v[148:151], v[44:47]
    v_mfma_f32_16x16x32_bf16 v[48:51], v[16:19], v[152:155], v[48:51]
    v_mfma_f32_16x16x32_bf16 v[52:55], v[16:19], v[156:159], v[52:55]
    v_mfma_f32_16x16x32_bf16 v[24:27], v[20:23], v[160:163], v[24:27]
    v_mfma_f32_16x16x32_bf16 v[28:31], v[20:23], v[164:167], v[28:31]
    v_mfma_f32_16x16x32_bf16 v[32:35], v[20:23], v[168:171], v[32:35]
    v_mfma_f32_16x16x32_bf16 v[36:39], v[20:23], v[172:175], v[36:39]
    v_mfma_f32_16x16x32_bf16 v[40:43], v[20:23], v[176:179], v[40:43]
    v_mfma_f32_16x16x32_bf16 v[44:47], v[20:23], v[180:183], v[44:47]
    v_mfma_f32_16x16x32_bf16 v[48:51], v[20:23], v[184:187], v[48:51]
    v_mfma_f32_16x16x32_bf16 v[52:55], v[20:23], v[188:191], v[52:55]
    s_lshl_b32 s40, s63, 7
    s_mul_i32 s41, s45, 278528
    s_add_u32 s40, s40, s41
    s_add_u32 s40, s40, 3145728
    v_lshrrev_b32 v8, 3, v2
    v_mul_u32_u24 v8, 34816, v8
    v_and_b32 v9, 7, v2
    v_lshl_add_u32 v8, v9, 4, v8
    v_add_u32 v8, s40, v8
    s_nop 3
    v_mov_b32 v192, v24
    v_mov_b32 v193, s39
    v_mov_b32 v194, v28
    v_mov_b32 v195, s39
    v_mov_b32 v196, v32
    v_mov_b32 v197, s39
    v_mov_b32 v198, v36
    v_mov_b32 v199, s39
    v_mov_b32 v200, v40
    v_mov_b32 v201, s39
    v_mov_b32 v202, v44
    v_mov_b32 v203, s39
    v_mov_b32 v204, v48
    v_mov_b32 v205, s39
    v_mov_b32 v206, v52
    v_mov_b32 v207, s39
    v_mov_b32 v208, v25
    v_mov_b32 v209, s39
    v_mov_b32 v210, v29
    v_mov_b32 v211, s39
    v_mov_b32 v212, v33
    v_mov_b32 v213, s39
    v_mov_b32 v214, v37
    v_mov_b32 v215, s39
    v_mov_b32 v216, v41
    v_mov_b32 v217, s39
    v_mov_b32 v218, v45
    v_mov_b32 v219, s39
    v_mov_b32 v220, v49
    v_mov_b32 v221, s39
    v_mov_b32 v222, v53
    v_mov_b32 v223, s39
    s_lshl_b32 s42, s34, 11
    s_add_u32 s42, s42, 16384
    v_lshl_add_u32 v9, v3, 6, s42
    s_mov_b64 exec, 0xffff
    ds_write_b128 v9, v[192:195] offset:0
    ds_write_b128 v9, v[196:199] offset:16
    ds_write_b128 v9, v[200:203] offset:32
    ds_write_b128 v9, v[204:207] offset:48
    ds_write_b128 v9, v[208:211] offset:1024
    ds_write_b128 v9, v[212:215] offset:1040
    ds_write_b128 v9, v[216:219] offset:1056
    ds_write_b128 v9, v[220:223] offset:1072
    s_mov_b64 exec, -1
    v_lshl_add_u32 v9, v2, 4, s42
    s_waitcnt lgkmcnt(0)
    ds_read_b128 v[192:195], v9
    ds_read_b128 v[196:199], v9 offset:1024
    v_add_u32 v9, 1392640, v8
    s_waitcnt lgkmcnt(1)
    global_store_dwordx4 v8, v[192:195], s[32:33] sc1
    s_waitcnt lgkmcnt(0)
    global_store_dwordx4 v9, v[196:199], s[32:33] sc1
    s_branch L_fin
L_B_w6:
    s_lshl_b32 s41, s36, 7
    v_lshl_add_u32 v9, v4, 3, s41
    v_lshlrev_b32 v9, 13, v9
    v_lshl_add_u32 v9, v3, 4, v9
    v_add_u32 v9, s44, v9
    v_add_u32 v8, 0, v9
    global_load_dwordx4 v[128:131], v8, s[12:13] nt
    v_add_u32 v8, 8192, v8
    global_load_dwordx4 v[132:135], v8, s[12:13] nt
    v_add_u32 v8, 8192, v8
    global_load_dwordx4 v[136:139], v8, s[12:13] nt
    v_add_u32 v8, 8192, v8
    global_load_dwordx4 v[140:143], v8, s[12:13] nt
    v_add_u32 v8, 8192, v8
    global_load_dwordx4 v[144:147], v8, s[12:13] nt
    v_add_u32 v8, 8192, v8
    global_load_dwordx4 v[148:151], v8, s[12:13] nt
    v_add_u32 v8, 8192, v8
    global_load_dwordx4 v[152:155], v8, s[12:13] nt
    v_add_u32 v8, 8192, v8
    global_load_dwordx4 v[156:159], v8, s[12:13] nt
    v_add_u32 v8, 262144, v9
    global_load_dwordx4 v[160:163], v8, s[12:13] nt
    v_add_u32 v8, 8192, v8
    global_load_dwordx4 v[164:167], v8, s[12:13] nt
    v_add_u32 v8, 8192, v8
    global_load_dwordx4 v[168:171], v8, s[12:13] nt
    v_add_u32 v8, 8192, v8
    global_load_dwordx4 v[172:175], v8, s[12:13] nt
    v_add_u32 v8, 8192, v8
    global_load_dwordx4 v[176:179], v8, s[12:13] nt
    v_add_u32 v8, 8192, v8
    global_load_dwordx4 v[180:183], v8, s[12:13] nt
    v_add_u32 v8, 8192, v8
    global_load_dwordx4 v[184:187], v8, s[12:13] nt
    v_add_u32 v8, 8192, v8
    global_load_dwordx4 v[188:191], v8, s[12:13] nt
    v_add_u32 v8, 524288, v9
    global_load_dwordx4 v[192:195], v8, s[12:13] nt
    v_add_u32 v8, 8192, v8
    global_load_dwordx4 v[196:199], v8, s[12:13] nt
    v_add_u32 v8, 8192, v8
    global_load_dwordx4 v[200:203], v8, s[12:13] nt
    v_add_u32 v8, 8192, v8
    global_load_dwordx4 v[204:207], v8, s[12:13] nt
    v_add_u32 v8, 8192, v8
    global_load_dwordx4 v[208:211], v8, s[12:13] nt
    v_add_u32 v8, 8192, v8
    global_load_dwordx4 v[212:215], v8, s[12:13] nt
    v_add_u32 v8, 8192, v8
    global_load_dwordx4 v[216:219], v8, s[12:13] nt
    v_add_u32 v8, 8192, v8
    global_load_dwordx4 v[220:223], v8, s[12:13] nt
    v_add_u32 v8, 786432, v9
    global_load_dwordx4 v[224:227], v8, s[12:13] nt
    v_add_u32 v8, 8192, v8
    global_load_dwordx4 v[228:231], v8, s[12:13] nt
    v_add_u32 v8, 8192, v8
    global_load_dwordx4 v[232:235], v8, s[12:13] nt
    v_add_u32 v8, 8192, v8
    global_load_dwordx4 v[236:239], v8, s[12:13] nt
    v_add_u32 v8, 8192, v8
    global_load_dwordx4 v[240:243], v8, s[12:13] nt
    v_add_u32 v8, 8192, v8
    global_load_dwordx4 v[244:247], v8, s[12:13] nt
    v_add_u32 v8, 8192, v8
    global_load_dwordx4 v[248:251], v8, s[12:13] nt
    v_add_u32 v8, 8192, v8
    global_load_dwordx4 v[252:255], v8, s[12:13] nt
    s_waitcnt vmcnt(0)
    v_perm_b32 v96, v132, v128, s37
    v_perm_b32 v97, v140, v136, s37
    v_perm_b32 v98, v148, v144, s37
    v_perm_b32 v99, v156, v152, s37
    v_perm_b32 v100, v132, v128, s38
    v_perm_b32 v101, v140, v136, s38
    v_perm_b32 v102, v148, v144, s38
    v_perm_b32 v103, v156, v152, s38
    v_perm_b32 v104, v133, v129, s37
    v_perm_b32 v105, v141, v137, s37
    v_perm_b32 v106, v149, v145, s37
    v_perm_b32 v107, v157, v153, s37
    v_perm_b32 v108, v133, v129, s38
    v_perm_b32 v109, v141, v137, s38
    v_perm_b32 v110, v149, v145, s38
    v_perm_b32 v111, v157, v153, s38
    v_perm_b32 v112, v134, v130, s37
    v_perm_b32 v113, v142, v138, s37
    v_perm_b32 v114, v150, v146, s37
    v_perm_b32 v115, v158, v154, s37
    v_perm_b32 v116, v134, v130, s38
    v_perm_b32 v117, v142, v138, s38
    v_perm_b32 v118, v150, v146, s38
    v_perm_b32 v119, v158, v154, s38
    v_perm_b32 v120, v135, v131, s37
    v_perm_b32 v121, v143, v139, s37
    v_perm_b32 v122, v151, v147, s37
    v_perm_b32 v123, v159, v155, s37
    v_perm_b32 v124, v135, v131, s38
    v_perm_b32 v125, v143, v139, s38
    v_perm_b32 v126, v151, v147, s38
    v_perm_b32 v127, v159, v155, s38
    v_perm_b32 v128, v164, v160, s37
    v_perm_b32 v129, v172, v168, s37
    v_perm_b32 v130, v180, v176, s37
    v_perm_b32 v131, v188, v184, s37
    v_perm_b32 v132, v164, v160, s38
    v_perm_b32 v133, v172, v168, s38
    v_perm_b32 v134, v180, v176, s38
    v_perm_b32 v135, v188, v184, s38
    v_perm_b32 v136, v165, v161, s37
    v_perm_b32 v137, v173, v169, s37
    v_perm_b32 v138, v181, v177, s37
    v_perm_b32 v139, v189, v185, s37
    v_perm_b32 v140, v165, v161, s38
    v_perm_b32 v141, v173, v169, s38
    v_perm_b32 v142, v181, v177, s38
    v_perm_b32 v143, v189, v185, s38
    v_perm_b32 v144, v166, v162, s37
    v_perm_b32 v145, v174, v170, s37
    v_perm_b32 v146, v182, v178, s37
    v_perm_b32 v147, v190, v186, s37
    v_perm_b32 v148, v166, v162, s38
    v_perm_b32 v149, v174, v170, s38
    v_perm_b32 v150, v182, v178, s38
    v_perm_b32 v151, v190, v186, s38
    v_perm_b32 v152, v167, v163, s37
    v_perm_b32 v153, v175, v171, s37
    v_perm_b32 v154, v183, v179, s37
    v_perm_b32 v155, v191, v187, s37
    v_perm_b32 v156, v167, v163, s38
    v_perm_b32 v157, v175, v171, s38
    v_perm_b32 v158, v183, v179, s38
    v_perm_b32 v159, v191, v187, s38
    v_perm_b32 v160, v196, v192, s37
    v_perm_b32 v161, v204, v200, s37
    v_perm_b32 v162, v212, v208, s37
    v_perm_b32 v163, v220, v216, s37
    v_perm_b32 v164, v196, v192, s38
    v_perm_b32 v165, v204, v200, s38
    v_perm_b32 v166, v212, v208, s38
    v_perm_b32 v167, v220, v216, s38
    v_perm_b32 v168, v197, v193, s37
    v_perm_b32 v169, v205, v201, s37
    v_perm_b32 v170, v213, v209, s37
    v_perm_b32 v171, v221, v217, s37
    v_perm_b32 v172, v197, v193, s38
    v_perm_b32 v173, v205, v201, s38
    v_perm_b32 v174, v213, v209, s38
    v_perm_b32 v175, v221, v217, s38
    v_perm_b32 v176, v198, v194, s37
    v_perm_b32 v177, v206, v202, s37
    v_perm_b32 v178, v214, v210, s37
    v_perm_b32 v179, v222, v218, s37
    v_perm_b32 v180, v198, v194, s38
    v_perm_b32 v181, v206, v202, s38
    v_perm_b32 v182, v214, v210, s38
    v_perm_b32 v183, v222, v218, s38
    v_perm_b32 v184, v199, v195, s37
    v_perm_b32 v185, v207, v203, s37
    v_perm_b32 v186, v215, v211, s37
    v_perm_b32 v187, v223, v219, s37
    v_perm_b32 v188, v199, v195, s38
    v_perm_b32 v189, v207, v203, s38
    v_perm_b32 v190, v215, v211, s38
    v_perm_b32 v191, v223, v219, s38
    v_perm_b32 v192, v228, v224, s37
    v_perm_b32 v193, v236, v232, s37
    v_perm_b32 v194, v244, v240, s37
    v_perm_b32 v195, v252, v248, s37
    v_perm_b32 v196, v228, v224, s38
    v_perm_b32 v197, v236, v232, s38
    v_perm_b32 v198, v244, v240, s38
    v_perm_b32 v199, v252, v248, s38
    v_perm_b32 v200, v229, v225, s37
    v_perm_b32 v201, v237, v233, s37
    v_perm_b32 v202, v245, v241, s37
    v_perm_b32 v203, v253, v249, s37
    v_perm_b32 v204, v229, v225, s38
    v_perm_b32 v205, v237, v233, s38
    v_perm_b32 v206, v245, v241, s38
    v_perm_b32 v207, v253, v249, s38
    v_perm_b32 v208, v230, v226, s37
    v_perm_b32 v209, v238, v234, s37
    v_perm_b32 v210, v246, v242, s37
    v_perm_b32 v211, v254, v250, s37
    v_perm_b32 v212, v230, v226, s38
    v_perm_b32 v213, v238, v234, s38
    v_perm_b32 v214, v246, v242, s38
    v_perm_b32 v215, v254, v250, s38
    v_perm_b32 v216, v231, v227, s37
    v_perm_b32 v217, v239, v235, s37
    v_perm_b32 v218, v247, v243, s37
    v_perm_b32 v219, v255, v251, s37
    v_perm_b32 v220, v231, v227, s38
    v_perm_b32 v221, v239, v235, s38
    v_perm_b32 v222, v247, v243, s38
    v_perm_b32 v223, v255, v251, s38
    v_mov_b32 v14, 0
    s_mov_b32 s41, 0
L_wf2:
    ds_read_b32 v15, v14 offset:7684
    s_add_u32 s41, s41, 1
    s_waitcnt lgkmcnt(0)
    v_cmp_gt_u32 vcc, 4, v15
    s_cmp_gt_u32 s41, 1048576
    s_cbranch_scc1 L_wf2_done
    s_cbranch_vccnz L_wf2
L_wf2_done:
    v_lshlrev_b32 v10, 3, v2
    ds_read_b64 v[16:17], v10 offset:9216
    ds_read_b64 v[18:19], v10 offset:9728
    ds_read_b64 v[20:21], v10 offset:10240
    ds_read_b64 v[22:23], v10 offset:10752
    s_waitcnt lgkmcnt(0)
    v_add_f32 v16, v16, v18
    v_add_f32 v17, v17, v19
    v_add_f32 v20, v20, v22
    v_add_f32 v21, v21, v23
    v_cvt_pk_bf16_f32 v16, v16, v17
    v_cvt_pk_bf16_f32 v17, v20, v21
    v_lshlrev_b32 v10, 2, v2
    ds_write_b32 v10, v16 offset:7872
    ds_write_b32 v10, v17 offset:8128
    v_and_b32 v5, 1, v3
    v_lshlrev_b32 v5, 8, v5
    v_lshl_add_u32 v5, v4, 4, v5
    s_waitcnt lgkmcnt(0)
    ds_read_b128 v[8:11], v5 offset:7872
    ds_read_b128 v[12:15], v5 offset:7936
    ds_read_b128 v[16:19], v5 offset:8000
    ds_read_b128 v[20:23], v5 offset:8064
    s_waitcnt lgkmcnt(0)
    v_mfma_f32_16x16x32_bf16 v[24:27], v[8:11], v[96:99], 0
    v_mfma_f32_16x16x32_bf16 v[28:31], v[8:11], v[100:103], 0
    v_mfma_f32_16x16x32_bf16 v[32:35], v[8:11], v[104:107], 0
    v_mfma_f32_16x16x32_bf16 v[36:39], v[8:11], v[108:111], 0
    v_mfma_f32_16x16x32_bf16 v[40:43], v[8:11], v[112:115], 0
    v_mfma_f32_16x16x32_bf16 v[44:47], v[8:11], v[116:119], 0
    v_mfma_f32_16x16x32_bf16 v[48:51], v[8:11], v[120:123], 0
    v_mfma_f32_16x16x32_bf16 v[52:55], v[8:11], v[124:127], 0
    v_mfma_f32_16x16x32_bf16 v[24:27], v[12:15], v[128:131], v[24:27]
    v_mfma_f32_16x16x32_bf16 v[28:31], v[12:15], v[132:135], v[28:31]
    v_mfma_f32_16x16x32_bf16 v[32:35], v[12:15], v[136:139], v[32:35]
    v_mfma_f32_16x16x32_bf16 v[36:39], v[12:15], v[140:143], v[36:39]
    v_mfma_f32_16x16x32_bf16 v[40:43], v[12:15], v[144:147], v[40:43]
    v_mfma_f32_16x16x32_bf16 v[44:47], v[12:15], v[148:151], v[44:47]
    v_mfma_f32_16x16x32_bf16 v[48:51], v[12:15], v[152:155], v[48:51]
    v_mfma_f32_16x16x32_bf16 v[52:55], v[12:15], v[156:159], v[52:55]
    v_mfma_f32_16x16x32_bf16 v[24:27], v[16:19], v[160:163], v[24:27]
    v_mfma_f32_16x16x32_bf16 v[28:31], v[16:19], v[164:167], v[28:31]
    v_mfma_f32_16x16x32_bf16 v[32:35], v[16:19], v[168:171], v[32:35]
    v_mfma_f32_16x16x32_bf16 v[36:39], v[16:19], v[172:175], v[36:39]
    v_mfma_f32_16x16x32_bf16 v[40:43], v[16:19], v[176:179], v[40:43]
    v_mfma_f32_16x16x32_bf16 v[44:47], v[16:19], v[180:183], v[44:47]
    v_mfma_f32_16x16x32_bf16 v[48:51], v[16:19], v[184:187], v[48:51]
    v_mfma_f32_16x16x32_bf16 v[52:55], v[16:19], v[188:191], v[52:55]
    v_mfma_f32_16x16x32_bf16 v[24:27], v[20:23], v[192:195], v[24:27]
    v_mfma_f32_16x16x32_bf16 v[28:31], v[20:23], v[196:199], v[28:31]
    v_mfma_f32_16x16x32_bf16 v[32:35], v[20:23], v[200:203], v[32:35]
    v_mfma_f32_16x16x32_bf16 v[36:39], v[20:23], v[204:207], v[36:39]
    v_mfma_f32_16x16x32_bf16 v[40:43], v[20:23], v[208:211], v[40:43]
    v_mfma_f32_16x16x32_bf16 v[44:47], v[20:23], v[212:215], v[44:47]
    v_mfma_f32_16x16x32_bf16 v[48:51], v[20:23], v[216:219], v[48:51]
    v_mfma_f32_16x16x32_bf16 v[52:55], v[20:23], v[220:223], v[52:55]
    v_lshlrev_b32 v5, 4, v3
    s_nop 7
    v_cvt_pk_bf16_f32 v64, v24, v28
    v_cvt_pk_bf16_f32 v65, v32, v36
    v_cvt_pk_bf16_f32 v66, v40, v44
    v_cvt_pk_bf16_f32 v67, v48, v52
    v_cvt_pk_bf16_f32 v68, v25, v29
    v_cvt_pk_bf16_f32 v69, v33, v37
    v_cvt_pk_bf16_f32 v70, v41, v45
    v_cvt_pk_bf16_f32 v71, v49, v53
    s_mov_b64 exec, 0xffff
    ds_write_b128 v5, v[64:67] offset:13312
    ds_write_b128 v5, v[68:71] offset:13568
    s_mov_b64 exec, -1
    s_waitcnt lgkmcnt(0)
    v_mov_b32 v14, 0
    v_mov_b32 v15, 1
    s_mov_b64 exec, 1
    ds_add_u32 v14, v15 offset:7688
    s_mov_b64 exec, -1
    s_branch L_fin
L_fin:
L_end:
    s_endpgm
.section .rodata,"a"
.p2align 6
.amdhsa_kernel gated_mix__compressed_kv_cla__dense_activation_squared_relu__decode_kernel
  .amdhsa_next_free_vgpr 256
  .amdhsa_next_free_sgpr 100
  .amdhsa_accum_offset 256
  .amdhsa_group_segment_fixed_size 0
  .amdhsa_kernarg_size 120
  .amdhsa_user_sgpr_count 2
  .amdhsa_user_sgpr_kernarg_segment_ptr 1
  .amdhsa_system_sgpr_workgroup_id_x 1
.end_amdhsa_kernel
```
